```python
import torch

def _softmax(x, axis=-1):
    return torch.softmax(x, dim=axis)
def _gelu(x):
    return torch.nn.functional.gelu(x, approximate="tanh")
def _silu(x):
    return torch.nn.functional.silu(x)
def _sigmoid(x):
    return torch.sigmoid(x)
def _layernorm(x, axis=-1, eps=1e-5):
    m = x.mean(dim=axis, keepdim=True)
    v = x.var(dim=axis, keepdim=True, unbiased=False)
    return (x - m) / torch.sqrt(v + eps)
def _scatter_add(tgt, idx, src, axis=0):
    return tgt.clone().index_add_(axis, idx, src)
def _segment_sum(src, seg, n):
    out = torch.zeros((n,) + src.shape[1:], dtype=src.dtype)
    return out.index_add_(0, seg, src)
def _pad(x, pw):
    flat = tuple(v for pair in reversed(pw) for v in pair)
    return torch.nn.functional.pad(x, flat)

kernel_name = 'recurrent_scan__sliding_block__dense_activation_relu__prompt'

def setup_inputs():

    _w = (lambda a: (lambda t: t.to(torch.bfloat16) if t.is_floating_point() else t)(torch.as_tensor(a)))
    def _A_setup():
        B, S, D = 1, 2048, 640
        return {
            "x": _w((lambda *s: torch.randn(*s, dtype=torch.bfloat16) * 0.05)(B, S, D)),
            "wqkv": _w((lambda *s: torch.randn(*s, dtype=torch.bfloat16) * 0.05)(D, 3 * D)),
            "wo": _w((lambda *s: torch.randn(*s, dtype=torch.bfloat16) * 0.05)(D, D)),
        }
    _A_in = _A_setup()

    def _B_setup():
        B, S, D, Dff = 1, 2048, 640, 1536
        return {
            "x": _w((lambda *s: torch.randn(*s, dtype=torch.bfloat16) * 0.05)(B, S, D)),
            "w1": _w((lambda *s: torch.randn(*s, dtype=torch.bfloat16) * 0.05)(D, Dff)),
            "w2": _w((lambda *s: torch.randn(*s, dtype=torch.bfloat16) * 0.05)(Dff, D)),
        }
    _B_in = _B_setup()

    return {
        "A_x": _A_in["x"],
        "A_wqkv": _A_in["wqkv"],
        "A_wo": _A_in["wo"],
        "B_x": _B_in["x"],
        "B_w1": _B_in["w1"],
        "B_w2": _B_in["w2"],
    }

def reference(A_x, A_wqkv, A_wo, B_x, B_w1, B_w2):
    def _A_ref(x, wqkv, wo):
        B, S, D = x.shape
        H = 32; Dh = D // H; W = 256
        qkv = (lambda x, *d: x.permute(*d))((x @ wqkv).reshape(B, S, 3, H, Dh), 2, 0, 3, 1, 4)
        q, k, v = qkv[0], qkv[1], qkv[2]
        scores = torch.einsum("bhqd,bhkd->bhqk", q, k) * (Dh ** -0.5)
        idx = torch.arange(S)
        mask = (idx[:, None] - idx[None, :] >= 0) & (idx[:, None] - idx[None, :] < W)
        scores = torch.where(mask[None, None], scores, -1e9)
        p = _softmax(scores, axis=-1)
        o = torch.einsum("bhqk,bhkd->bhqd", p, v)
        return (lambda x, *d: x.permute(*d))(o, 0, 2, 1, 3).reshape(B, S, D) @ wo

    def _B_ref(x, w1, w2):
        h = torch.einsum("bsd,df->bsf", x, w1)
        zero = torch.zeros_like(h)
        h = torch.maximum(h, zero)
        return torch.einsum("bsf,fd->bsd", h, w2)

    x = A_x
    xn = _layernorm(x, axis=-1)
    s = _A_ref(xn, A_wqkv, A_wo)
    g = _silu(_B_ref(xn, B_w1, B_w2))
    return x + s * g
```

```asm
; @launch kernel=ln_kernel grid=(128,1,1) block=(256,1,1) lds=0
; @launch kernel=gemm1_kernel grid=(256,1,1) block=(256,1,1) lds=147456
; @launch kernel=mid_kernel grid=(672,1,1) block=(256,1,1) lds=98304
; @launch kernel=recurrent_scan__sliding_block__dense_activation_relu__prompt_kernel grid=(80,1,1) block=(256,1,1) lds=98304
.amdgcn_target "amdgcn-amd-amdhsa--gfx950"
.text
.globl ln_kernel
.p2align 8
.type ln_kernel,@function
ln_kernel:
    s_cmp_ge_u32 s2, 128
    s_cbranch_scc1 ln_kernel_done1
    s_load_dwordx2 s[4:5], s[0:1], 0
    s_load_dwordx2 s[6:7], s[0:1], 64
    v_lshrrev_b32 v1, 4, v0
    s_lshl_b32 s3, s2, 4
    v_add_u32 v1, s3, v1
    v_mul_u32_u24 v2, 1280, v1
    v_and_b32 v3, 15, v0
    v_lshl_add_u32 v2, v3, 4, v2
    s_waitcnt lgkmcnt(0)
    s_mov_b32 s8, s4
    s_and_b32 s9, s5, 0xffff
    s_mov_b32 s10, 2621440
    s_mov_b32 s11, 0x00020000
    s_add_u32 s12, s6, 0
    s_addc_u32 s13, s7, 0
    s_and_b32 s13, s13, 0xffff
    s_mov_b32 s14, 2621440
    s_mov_b32 s15, 0x00020000
    buffer_load_dwordx4 v[4:7], v2, s[8:11], 0 offen offset:0
    buffer_load_dwordx4 v[8:11], v2, s[8:11], 0 offen offset:256
    buffer_load_dwordx4 v[12:15], v2, s[8:11], 0 offen offset:512
    buffer_load_dwordx4 v[16:19], v2, s[8:11], 0 offen offset:768
    buffer_load_dwordx4 v[20:23], v2, s[8:11], 0 offen offset:1024
    s_waitcnt vmcnt(0)
    v_lshlrev_b32 v32, 16, v4
    v_and_b32 v33, 0xffff0000, v4
    v_lshlrev_b32 v34, 16, v5
    v_and_b32 v35, 0xffff0000, v5
    v_lshlrev_b32 v36, 16, v6
    v_and_b32 v37, 0xffff0000, v6
    v_lshlrev_b32 v38, 16, v7
    v_and_b32 v39, 0xffff0000, v7
    v_lshlrev_b32 v40, 16, v8
    v_and_b32 v41, 0xffff0000, v8
    v_lshlrev_b32 v42, 16, v9
    v_and_b32 v43, 0xffff0000, v9
    v_lshlrev_b32 v44, 16, v10
    v_and_b32 v45, 0xffff0000, v10
    v_lshlrev_b32 v46, 16, v11
    v_and_b32 v47, 0xffff0000, v11
    v_lshlrev_b32 v48, 16, v12
    v_and_b32 v49, 0xffff0000, v12
    v_lshlrev_b32 v50, 16, v13
    v_and_b32 v51, 0xffff0000, v13
    v_lshlrev_b32 v52, 16, v14
    v_and_b32 v53, 0xffff0000, v14
    v_lshlrev_b32 v54, 16, v15
    v_and_b32 v55, 0xffff0000, v15
    v_lshlrev_b32 v56, 16, v16
    v_and_b32 v57, 0xffff0000, v16
    v_lshlrev_b32 v58, 16, v17
    v_and_b32 v59, 0xffff0000, v17
    v_lshlrev_b32 v60, 16, v18
    v_and_b32 v61, 0xffff0000, v18
    v_lshlrev_b32 v62, 16, v19
    v_and_b32 v63, 0xffff0000, v19
    v_lshlrev_b32 v64, 16, v20
    v_and_b32 v65, 0xffff0000, v20
    v_lshlrev_b32 v66, 16, v21
    v_and_b32 v67, 0xffff0000, v21
    v_lshlrev_b32 v68, 16, v22
    v_and_b32 v69, 0xffff0000, v22
    v_lshlrev_b32 v70, 16, v23
    v_and_b32 v71, 0xffff0000, v23
    v_add_f32 v72, v32, v33
    v_add_f32 v73, v34, v35
    v_add_f32 v72, v72, v36
    v_add_f32 v73, v73, v37
    v_add_f32 v72, v72, v38
    v_add_f32 v73, v73, v39
    v_add_f32 v72, v72, v40
    v_add_f32 v73, v73, v41
    v_add_f32 v72, v72, v42
    v_add_f32 v73, v73, v43
    v_add_f32 v72, v72, v44
    v_add_f32 v73, v73, v45
    v_add_f32 v72, v72, v46
    v_add_f32 v73, v73, v47
    v_add_f32 v72, v72, v48
    v_add_f32 v73, v73, v49
    v_add_f32 v72, v72, v50
    v_add_f32 v73, v73, v51
    v_add_f32 v72, v72, v52
    v_add_f32 v73, v73, v53
    v_add_f32 v72, v72, v54
    v_add_f32 v73, v73, v55
    v_add_f32 v72, v72, v56
    v_add_f32 v73, v73, v57
    v_add_f32 v72, v72, v58
    v_add_f32 v73, v73, v59
    v_add_f32 v72, v72, v60
    v_add_f32 v73, v73, v61
    v_add_f32 v72, v72, v62
    v_add_f32 v73, v73, v63
    v_add_f32 v72, v72, v64
    v_add_f32 v73, v73, v65
    v_add_f32 v72, v72, v66
    v_add_f32 v73, v73, v67
    v_add_f32 v72, v72, v68
    v_add_f32 v73, v73, v69
    v_add_f32 v72, v72, v70
    v_add_f32 v73, v73, v71
    v_add_f32 v72, v72, v73
    s_nop 1
    v_add_f32_dpp v74, v72, v72 row_ror:8 row_mask:0xf bank_mask:0xf
    v_mov_b32 v72, v74
    s_nop 1
    v_add_f32_dpp v74, v72, v72 row_ror:4 row_mask:0xf bank_mask:0xf
    v_mov_b32 v72, v74
    s_nop 1
    v_add_f32_dpp v74, v72, v72 row_ror:2 row_mask:0xf bank_mask:0xf
    v_mov_b32 v72, v74
    s_nop 1
    v_add_f32_dpp v74, v72, v72 row_ror:1 row_mask:0xf bank_mask:0xf
    v_mov_b32 v72, v74
    v_mul_f32 v72, 0.0015625, v72
    v_sub_f32 v32, v32, v72
    v_sub_f32 v33, v33, v72
    v_sub_f32 v34, v34, v72
    v_sub_f32 v35, v35, v72
    v_sub_f32 v36, v36, v72
    v_sub_f32 v37, v37, v72
    v_sub_f32 v38, v38, v72
    v_sub_f32 v39, v39, v72
    v_sub_f32 v40, v40, v72
    v_sub_f32 v41, v41, v72
    v_sub_f32 v42, v42, v72
    v_sub_f32 v43, v43, v72
    v_sub_f32 v44, v44, v72
    v_sub_f32 v45, v45, v72
    v_sub_f32 v46, v46, v72
    v_sub_f32 v47, v47, v72
    v_sub_f32 v48, v48, v72
    v_sub_f32 v49, v49, v72
    v_sub_f32 v50, v50, v72
    v_sub_f32 v51, v51, v72
    v_sub_f32 v52, v52, v72
    v_sub_f32 v53, v53, v72
    v_sub_f32 v54, v54, v72
    v_sub_f32 v55, v55, v72
    v_sub_f32 v56, v56, v72
    v_sub_f32 v57, v57, v72
    v_sub_f32 v58, v58, v72
    v_sub_f32 v59, v59, v72
    v_sub_f32 v60, v60, v72
    v_sub_f32 v61, v61, v72
    v_sub_f32 v62, v62, v72
    v_sub_f32 v63, v63, v72
    v_sub_f32 v64, v64, v72
    v_sub_f32 v65, v65, v72
    v_sub_f32 v66, v66, v72
    v_sub_f32 v67, v67, v72
    v_sub_f32 v68, v68, v72
    v_sub_f32 v69, v69, v72
    v_sub_f32 v70, v70, v72
    v_sub_f32 v71, v71, v72
    v_mul_f32 v73, v32, v32
    v_mul_f32 v75, v33, v33
    v_fmac_f32 v73, v34, v34
    v_fmac_f32 v75, v35, v35
    v_fmac_f32 v73, v36, v36
    v_fmac_f32 v75, v37, v37
    v_fmac_f32 v73, v38, v38
    v_fmac_f32 v75, v39, v39
    v_fmac_f32 v73, v40, v40
    v_fmac_f32 v75, v41, v41
    v_fmac_f32 v73, v42, v42
    v_fmac_f32 v75, v43, v43
    v_fmac_f32 v73, v44, v44
    v_fmac_f32 v75, v45, v45
    v_fmac_f32 v73, v46, v46
    v_fmac_f32 v75, v47, v47
    v_fmac_f32 v73, v48, v48
    v_fmac_f32 v75, v49, v49
    v_fmac_f32 v73, v50, v50
    v_fmac_f32 v75, v51, v51
    v_fmac_f32 v73, v52, v52
    v_fmac_f32 v75, v53, v53
    v_fmac_f32 v73, v54, v54
    v_fmac_f32 v75, v55, v55
    v_fmac_f32 v73, v56, v56
    v_fmac_f32 v75, v57, v57
    v_fmac_f32 v73, v58, v58
    v_fmac_f32 v75, v59, v59
    v_fmac_f32 v73, v60, v60
    v_fmac_f32 v75, v61, v61
    v_fmac_f32 v73, v62, v62
    v_fmac_f32 v75, v63, v63
    v_fmac_f32 v73, v64, v64
    v_fmac_f32 v75, v65, v65
    v_fmac_f32 v73, v66, v66
    v_fmac_f32 v75, v67, v67
    v_fmac_f32 v73, v68, v68
    v_fmac_f32 v75, v69, v69
    v_fmac_f32 v73, v70, v70
    v_fmac_f32 v75, v71, v71
    v_add_f32 v73, v73, v75
    s_nop 1
    v_add_f32_dpp v74, v73, v73 row_ror:8 row_mask:0xf bank_mask:0xf
    v_mov_b32 v73, v74
    s_nop 1
    v_add_f32_dpp v74, v73, v73 row_ror:4 row_mask:0xf bank_mask:0xf
    v_mov_b32 v73, v74
    s_nop 1
    v_add_f32_dpp v74, v73, v73 row_ror:2 row_mask:0xf bank_mask:0xf
    v_mov_b32 v73, v74
    s_nop 1
    v_add_f32_dpp v74, v73, v73 row_ror:1 row_mask:0xf bank_mask:0xf
    v_mov_b32 v73, v74
    v_mov_b32 v75, 1e-05
    v_fmac_f32 v75, 0.0015625, v73
    v_rsq_f32 v75, v75
    s_nop 0
    v_mul_f32 v32, v32, v75
    v_mul_f32 v33, v33, v75
    v_mul_f32 v34, v34, v75
    v_mul_f32 v35, v35, v75
    v_mul_f32 v36, v36, v75
    v_mul_f32 v37, v37, v75
    v_mul_f32 v38, v38, v75
    v_mul_f32 v39, v39, v75
    v_mul_f32 v40, v40, v75
    v_mul_f32 v41, v41, v75
    v_mul_f32 v42, v42, v75
    v_mul_f32 v43, v43, v75
    v_mul_f32 v44, v44, v75
    v_mul_f32 v45, v45, v75
    v_mul_f32 v46, v46, v75
    v_mul_f32 v47, v47, v75
    v_mul_f32 v48, v48, v75
    v_mul_f32 v49, v49, v75
    v_mul_f32 v50, v50, v75
    v_mul_f32 v51, v51, v75
    v_mul_f32 v52, v52, v75
    v_mul_f32 v53, v53, v75
    v_mul_f32 v54, v54, v75
    v_mul_f32 v55, v55, v75
    v_mul_f32 v56, v56, v75
    v_mul_f32 v57, v57, v75
    v_mul_f32 v58, v58, v75
    v_mul_f32 v59, v59, v75
    v_mul_f32 v60, v60, v75
    v_mul_f32 v61, v61, v75
    v_mul_f32 v62, v62, v75
    v_mul_f32 v63, v63, v75
    v_mul_f32 v64, v64, v75
    v_mul_f32 v65, v65, v75
    v_mul_f32 v66, v66, v75
    v_mul_f32 v67, v67, v75
    v_mul_f32 v68, v68, v75
    v_mul_f32 v69, v69, v75
    v_mul_f32 v70, v70, v75
    v_mul_f32 v71, v71, v75
    v_cvt_pk_bf16_f32 v4, v32, v33
    v_cvt_pk_bf16_f32 v5, v34, v35
    v_cvt_pk_bf16_f32 v6, v36, v37
    v_cvt_pk_bf16_f32 v7, v38, v39
    v_cvt_pk_bf16_f32 v8, v40, v41
    v_cvt_pk_bf16_f32 v9, v42, v43
    v_cvt_pk_bf16_f32 v10, v44, v45
    v_cvt_pk_bf16_f32 v11, v46, v47
    v_cvt_pk_bf16_f32 v12, v48, v49
    v_cvt_pk_bf16_f32 v13, v50, v51
    v_cvt_pk_bf16_f32 v14, v52, v53
    v_cvt_pk_bf16_f32 v15, v54, v55
    v_cvt_pk_bf16_f32 v16, v56, v57
    v_cvt_pk_bf16_f32 v17, v58, v59
    v_cvt_pk_bf16_f32 v18, v60, v61
    v_cvt_pk_bf16_f32 v19, v62, v63
    v_cvt_pk_bf16_f32 v20, v64, v65
    v_cvt_pk_bf16_f32 v21, v66, v67
    v_cvt_pk_bf16_f32 v22, v68, v69
    v_cvt_pk_bf16_f32 v23, v70, v71
    buffer_store_dwordx4 v[4:7], v2, s[12:15], 0 offen offset:0
    buffer_store_dwordx4 v[8:11], v2, s[12:15], 0 offen offset:256
    buffer_store_dwordx4 v[12:15], v2, s[12:15], 0 offen offset:512
    buffer_store_dwordx4 v[16:19], v2, s[12:15], 0 offen offset:768
    buffer_store_dwordx4 v[20:23], v2, s[12:15], 0 offen offset:1024
ln_kernel_done1:
    s_endpgm
.globl gemm1_kernel
.p2align 8
.type gemm1_kernel,@function
gemm1_kernel:
    s_cmp_ge_u32 s2, 256
    s_cbranch_scc1 gemm1_kernel_done1
    s_and_b32 s20, s2, 7
    s_lshr_b32 s21, s2, 3
    s_and_b32 s22, s21, 3
    s_lshl_b32 s22, s22, 3
    s_add_u32 s20, s20, s22
    s_lshr_b32 s21, s21, 2
    s_cmp_ge_u32 s20, 27
    s_cbranch_scc1 gemm1_kernel_done1
    s_load_dwordx2 s[4:5], s[0:1], 8
    s_load_dwordx2 s[6:7], s[0:1], 32
    s_load_dwordx2 s[24:25], s[0:1], 64
    s_waitcnt lgkmcnt(0)
    s_add_u32 s8, s24, 0
    s_addc_u32 s9, s25, 0
    s_and_b32 s9, s9, 0xffff
    s_mov_b32 s10, 2621440
    s_mov_b32 s11, 0x00020000
    s_add_u32 s16, s24, 2621440
    s_addc_u32 s17, s25, 0
    s_and_b32 s17, s17, 0xffff
    s_mov_b32 s18, 14155776
    s_mov_b32 s19, 0x00020000
    s_mov_b32 s14, 1966080
    s_mov_b32 s26, 3072
    s_mov_b32 s29, 0
    s_cmp_lt_u32 s20, 15
    s_cselect_b32 s12, s4, s6
    s_cselect_b32 s13, s5, s7
    s_cselect_b32 s14, 2457600, s14
    s_cselect_b32 s26, 3840, s26
    s_cselect_b32 s27, 0, 15
    s_cselect_b32 s29, 0xff7fffff, s29
    s_and_b32 s13, s13, 0xffff
    s_mov_b32 s15, 0x00020000
    s_sub_u32 s27, s20, s27
    s_lshl_b32 s27, s27, 8
    s_mul_i32 s28, s21, 327680
    v_lshrrev_b32 v23, 6, v0
    s_nop 0
    v_readfirstlane_b32 s40, v23
    v_and_b32 v24, 63, v0
    v_lshrrev_b32 v25, 3, v24
    v_mul_u32_u24 v8, 1280, v25
    v_lshrrev_b32 v25, 4, v24
    v_and_b32 v9, 7, v24
    v_xor_b32 v25, v25, v9
    v_xor_b32 v9, 4, v25
    v_lshl_add_u32 v9, v9, 4, v8
    v_lshl_add_u32 v8, v25, 4, v8
    v_lshrrev_b32 v25, 4, v24
    v_mul_lo_u32 v10, v25, s26
    v_lshlrev_b32 v25, 2, v25
    v_and_b32 v11, 15, v24
    v_xor_b32 v25, v25, v11
    v_lshl_add_u32 v10, v25, 4, v10
    s_mul_i32 s41, s40, 81920
    s_add_u32 s41, s41, s28
    s_lshl_b32 s43, s40, 4
    s_mul_i32 s42, s43, s26
    s_add_u32 s42, s42, s27
    s_lshr_b32 s43, s40, 1
    s_mul_i32 s43, s43, 16384
    v_and_b32 v25, 31, v24
    v_lshl_add_u32 v23, v25, 7, s43
    v_bfe_u32 v25, v24, 1, 3
    v_lshrrev_b32 v17, 5, v24
    v_add_u32 v18, 0, v17
    v_xor_b32 v18, v18, v25
    v_lshl_add_u32 v11, v18, 4, v23
    v_add_u32 v18, 2, v17
    v_xor_b32 v18, v18, v25
    v_lshl_add_u32 v12, v18, 4, v23
    v_add_u32 v18, 4, v17
    v_xor_b32 v18, v18, v25
    v_lshl_add_u32 v13, v18, 4, v23
    v_add_u32 v18, 6, v17
    v_xor_b32 v18, v18, v25
    v_lshl_add_u32 v14, v18, 4, v23
    v_lshrrev_b32 v23, 5, v24
    v_lshlrev_b32 v23, 3, v23
    v_bfe_u32 v25, v24, 2, 2
    v_add_u32 v23, v23, v25
    v_lshlrev_b32 v23, 8, v23
    v_bfe_u32 v18, v24, 4, 1
    v_lshl_add_u32 v23, v18, 5, v23
    v_and_b32 v18, 3, v24
    v_lshl_add_u32 v23, v18, 3, v23
    v_add_u32 v23, 32768, v23
    s_and_b32 s43, s40, 1
    s_lshl_b32 s43, s43, 1
    s_add_u32 s44, s43, 0
    v_xor_b32 v18, s44, v25
    v_lshl_add_u32 v15, v18, 6, v23
    s_add_u32 s44, s43, 1
    v_xor_b32 v18, s44, v25
    v_lshl_add_u32 v16, v18, 6, v23
    s_mul_i32 s44, s40, 8192
    s_add_u32 m0, s44, 0
    s_add_u32 s43, s41, 0
    buffer_load_dwordx4 v8, s[8:11], s43 offen lds
    s_mul_i32 s44, s40, 8192
    s_add_u32 m0, s44, 1024
    s_add_u32 s43, s41, 10240
    buffer_load_dwordx4 v9, s[8:11], s43 offen lds
    s_mul_i32 s44, s40, 8192
    s_add_u32 m0, s44, 2048
    s_add_u32 s43, s41, 20480
    buffer_load_dwordx4 v8, s[8:11], s43 offen lds
    s_mul_i32 s44, s40, 8192
    s_add_u32 m0, s44, 3072
    s_add_u32 s43, s41, 30720
    buffer_load_dwordx4 v9, s[8:11], s43 offen lds
    s_mul_i32 s44, s40, 8192
    s_add_u32 m0, s44, 4096
    s_add_u32 s43, s41, 40960
    buffer_load_dwordx4 v8, s[8:11], s43 offen lds
    s_mul_i32 s44, s40, 8192
    s_add_u32 m0, s44, 5120
    s_add_u32 s43, s41, 51200
    buffer_load_dwordx4 v9, s[8:11], s43 offen lds
    s_mul_i32 s44, s40, 8192
    s_add_u32 m0, s44, 6144
    s_add_u32 s43, s41, 61440
    buffer_load_dwordx4 v8, s[8:11], s43 offen lds
    s_mul_i32 s44, s40, 8192
    s_add_u32 m0, s44, 7168
    s_add_u32 s43, s41, 71680
    buffer_load_dwordx4 v9, s[8:11], s43 offen lds
    s_lshl_b32 s44, s40, 12
    s_add_u32 m0, s44, 32768
    s_mul_i32 s43, s26, 0
    s_add_u32 s43, s43, s42
    buffer_load_dwordx4 v10, s[12:15], s43 offen lds
    s_lshl_b32 s44, s40, 12
    s_add_u32 m0, s44, 33792
    s_mul_i32 s43, s26, 4
    s_add_u32 s43, s43, s42
    buffer_load_dwordx4 v10, s[12:15], s43 offen lds
    s_lshl_b32 s44, s40, 12
    s_add_u32 m0, s44, 34816
    s_mul_i32 s43, s26, 8
    s_add_u32 s43, s43, s42
    buffer_load_dwordx4 v10, s[12:15], s43 offen lds
    s_lshl_b32 s44, s40, 12
    s_add_u32 m0, s44, 35840
    s_mul_i32 s43, s26, 12
    s_add_u32 s43, s43, s42
    buffer_load_dwordx4 v10, s[12:15], s43 offen lds
    s_mul_i32 s44, s40, 8192
    s_add_u32 m0, s44, 49152
    s_add_u32 s43, s41, 128
    buffer_load_dwordx4 v8, s[8:11], s43 offen lds
    s_mul_i32 s44, s40, 8192
    s_add_u32 m0, s44, 50176
    s_add_u32 s43, s41, 10368
    buffer_load_dwordx4 v9, s[8:11], s43 offen lds
    s_mul_i32 s44, s40, 8192
    s_add_u32 m0, s44, 51200
    s_add_u32 s43, s41, 20608
    buffer_load_dwordx4 v8, s[8:11], s43 offen lds
    s_mul_i32 s44, s40, 8192
    s_add_u32 m0, s44, 52224
    s_add_u32 s43, s41, 30848
    buffer_load_dwordx4 v9, s[8:11], s43 offen lds
    s_mul_i32 s44, s40, 8192
    s_add_u32 m0, s44, 53248
    s_add_u32 s43, s41, 41088
    buffer_load_dwordx4 v8, s[8:11], s43 offen lds
    s_mul_i32 s44, s40, 8192
    s_add_u32 m0, s44, 54272
    s_add_u32 s43, s41, 51328
    buffer_load_dwordx4 v9, s[8:11], s43 offen lds
    s_mul_i32 s44, s40, 8192
    s_add_u32 m0, s44, 55296
    s_add_u32 s43, s41, 61568
    buffer_load_dwordx4 v8, s[8:11], s43 offen lds
    s_mul_i32 s44, s40, 8192
    s_add_u32 m0, s44, 56320
    s_add_u32 s43, s41, 71808
    buffer_load_dwordx4 v9, s[8:11], s43 offen lds
    s_lshl_b32 s44, s40, 12
    s_add_u32 m0, s44, 81920
    s_mul_i32 s43, s26, 64
    s_add_u32 s43, s43, s42
    buffer_load_dwordx4 v10, s[12:15], s43 offen lds
    s_lshl_b32 s44, s40, 12
    s_add_u32 m0, s44, 82944
    s_mul_i32 s43, s26, 68
    s_add_u32 s43, s43, s42
    buffer_load_dwordx4 v10, s[12:15], s43 offen lds
    s_lshl_b32 s44, s40, 12
    s_add_u32 m0, s44, 83968
    s_mul_i32 s43, s26, 72
    s_add_u32 s43, s43, s42
    buffer_load_dwordx4 v10, s[12:15], s43 offen lds
    s_lshl_b32 s44, s40, 12
    s_add_u32 m0, s44, 84992
    s_mul_i32 s43, s26, 76
    s_add_u32 s43, s43, s42
    buffer_load_dwordx4 v10, s[12:15], s43 offen lds
    s_mul_i32 s44, s40, 8192
    s_add_u32 m0, s44, 98304
    s_add_u32 s43, s41, 256
    buffer_load_dwordx4 v8, s[8:11], s43 offen lds
    s_mul_i32 s44, s40, 8192
    s_add_u32 m0, s44, 99328
    s_add_u32 s43, s41, 10496
    buffer_load_dwordx4 v9, s[8:11], s43 offen lds
    s_mul_i32 s44, s40, 8192
    s_add_u32 m0, s44, 100352
    s_add_u32 s43, s41, 20736
    buffer_load_dwordx4 v8, s[8:11], s43 offen lds
    s_mul_i32 s44, s40, 8192
    s_add_u32 m0, s44, 101376
    s_add_u32 s43, s41, 30976
    buffer_load_dwordx4 v9, s[8:11], s43 offen lds
    s_mul_i32 s44, s40, 8192
    s_add_u32 m0, s44, 102400
    s_add_u32 s43, s41, 41216
    buffer_load_dwordx4 v8, s[8:11], s43 offen lds
    s_mul_i32 s44, s40, 8192
    s_add_u32 m0, s44, 103424
    s_add_u32 s43, s41, 51456
    buffer_load_dwordx4 v9, s[8:11], s43 offen lds
    s_mul_i32 s44, s40, 8192
    s_add_u32 m0, s44, 104448
    s_add_u32 s43, s41, 61696
    buffer_load_dwordx4 v8, s[8:11], s43 offen lds
    s_mul_i32 s44, s40, 8192
    s_add_u32 m0, s44, 105472
    s_add_u32 s43, s41, 71936
    buffer_load_dwordx4 v9, s[8:11], s43 offen lds
    s_lshl_b32 s44, s40, 12
    s_add_u32 m0, s44, 131072
    s_mul_i32 s43, s26, 128
    s_add_u32 s43, s43, s42
    buffer_load_dwordx4 v10, s[12:15], s43 offen lds
    s_lshl_b32 s44, s40, 12
    s_add_u32 m0, s44, 132096
    s_mul_i32 s43, s26, 132
    s_add_u32 s43, s43, s42
    buffer_load_dwordx4 v10, s[12:15], s43 offen lds
    s_lshl_b32 s44, s40, 12
    s_add_u32 m0, s44, 133120
    s_mul_i32 s43, s26, 136
    s_add_u32 s43, s43, s42
    buffer_load_dwordx4 v10, s[12:15], s43 offen lds
    s_lshl_b32 s44, s40, 12
    s_add_u32 m0, s44, 134144
    s_mul_i32 s43, s26, 140
    s_add_u32 s43, s43, s42
    buffer_load_dwordx4 v10, s[12:15], s43 offen lds
    s_waitcnt vmcnt(24)
    s_barrier
    v_add_u32 v17, 0, v11
    v_add_u32 v18, 0, v12
    v_add_u32 v19, 0, v13
    v_add_u32 v20, 0, v14
    v_add_u32 v21, 0, v15
    v_add_u32 v22, 0, v16
    ds_read_b128 v[28:31], v17 offset:0
    ds_read_b128 v[32:35], v17 offset:4096
    ds_read_b128 v[36:39], v17 offset:8192
    ds_read_b128 v[40:43], v17 offset:12288
    ds_read_b64_tr_b16 v[60:61], v21 offset:0
    ds_read_b64_tr_b16 v[62:63], v21 offset:1024
    ds_read_b64_tr_b16 v[64:65], v22 offset:0
    ds_read_b64_tr_b16 v[66:67], v22 offset:1024
    ds_read_b128 v[44:47], v18 offset:0
    ds_read_b128 v[48:51], v18 offset:4096
    ds_read_b128 v[52:55], v18 offset:8192
    ds_read_b128 v[56:59], v18 offset:12288
    ds_read_b64_tr_b16 v[68:69], v21 offset:4096
    ds_read_b64_tr_b16 v[70:71], v21 offset:5120
    ds_read_b64_tr_b16 v[72:73], v22 offset:4096
    ds_read_b64_tr_b16 v[74:75], v22 offset:5120
    s_waitcnt lgkmcnt(8)
    v_mfma_f32_32x32x16_bf16 a[0:15], v[60:63], v[28:31], 0
    v_mfma_f32_32x32x16_bf16 a[16:31], v[64:67], v[28:31], 0
    v_mfma_f32_32x32x16_bf16 a[32:47], v[60:63], v[32:35], 0
    v_mfma_f32_32x32x16_bf16 a[48:63], v[64:67], v[32:35], 0
    v_mfma_f32_32x32x16_bf16 a[64:79], v[60:63], v[36:39], 0
    v_mfma_f32_32x32x16_bf16 a[80:95], v[64:67], v[36:39], 0
    v_mfma_f32_32x32x16_bf16 a[96:111], v[60:63], v[40:43], 0
    v_mfma_f32_32x32x16_bf16 a[112:127], v[64:67], v[40:43], 0
    ds_read_b128 v[28:31], v19 offset:0
    ds_read_b128 v[32:35], v19 offset:4096
    ds_read_b128 v[36:39], v19 offset:8192
    ds_read_b128 v[40:43], v19 offset:12288
    ds_read_b64_tr_b16 v[60:61], v21 offset:8192
    ds_read_b64_tr_b16 v[62:63], v21 offset:9216
    ds_read_b64_tr_b16 v[64:65], v22 offset:8192
    ds_read_b64_tr_b16 v[66:67], v22 offset:9216
    s_waitcnt lgkmcnt(8)
    v_mfma_f32_32x32x16_bf16 a[0:15], v[68:71], v[44:47], a[0:15]
    v_mfma_f32_32x32x16_bf16 a[16:31], v[72:75], v[44:47], a[16:31]
    v_mfma_f32_32x32x16_bf16 a[32:47], v[68:71], v[48:51], a[32:47]
    v_mfma_f32_32x32x16_bf16 a[48:63], v[72:75], v[48:51], a[48:63]
    v_mfma_f32_32x32x16_bf16 a[64:79], v[68:71], v[52:55], a[64:79]
    v_mfma_f32_32x32x16_bf16 a[80:95], v[72:75], v[52:55], a[80:95]
    v_mfma_f32_32x32x16_bf16 a[96:111], v[68:71], v[56:59], a[96:111]
    v_mfma_f32_32x32x16_bf16 a[112:127], v[72:75], v[56:59], a[112:127]
    ds_read_b128 v[44:47], v20 offset:0
    ds_read_b128 v[48:51], v20 offset:4096
    ds_read_b128 v[52:55], v20 offset:8192
    ds_read_b128 v[56:59], v20 offset:12288
    ds_read_b64_tr_b16 v[68:69], v21 offset:12288
    ds_read_b64_tr_b16 v[70:71], v21 offset:13312
    ds_read_b64_tr_b16 v[72:73], v22 offset:12288
    ds_read_b64_tr_b16 v[74:75], v22 offset:13312
    s_waitcnt lgkmcnt(8)
    v_mfma_f32_32x32x16_bf16 a[0:15], v[60:63], v[28:31], a[0:15]
    v_mfma_f32_32x32x16_bf16 a[16:31], v[64:67], v[28:31], a[16:31]
    v_mfma_f32_32x32x16_bf16 a[32:47], v[60:63], v[32:35], a[32:47]
    v_mfma_f32_32x32x16_bf16 a[48:63], v[64:67], v[32:35], a[48:63]
    v_mfma_f32_32x32x16_bf16 a[64:79], v[60:63], v[36:39], a[64:79]
    v_mfma_f32_32x32x16_bf16 a[80:95], v[64:67], v[36:39], a[80:95]
    v_mfma_f32_32x32x16_bf16 a[96:111], v[60:63], v[40:43], a[96:111]
    v_mfma_f32_32x32x16_bf16 a[112:127], v[64:67], v[40:43], a[112:127]
    s_waitcnt lgkmcnt(0)
    s_waitcnt vmcnt(12)
    s_barrier
    s_mul_i32 s44, s40, 8192
    s_add_u32 m0, s44, 0
    s_add_u32 s43, s41, 384
    buffer_load_dwordx4 v8, s[8:11], s43 offen lds
    s_mul_i32 s44, s40, 8192
    s_add_u32 m0, s44, 1024
    s_add_u32 s43, s41, 10624
    buffer_load_dwordx4 v9, s[8:11], s43 offen lds
    s_mul_i32 s44, s40, 8192
    s_add_u32 m0, s44, 2048
    s_add_u32 s43, s41, 20864
    buffer_load_dwordx4 v8, s[8:11], s43 offen lds
    s_mul_i32 s44, s40, 8192
    s_add_u32 m0, s44, 3072
    s_add_u32 s43, s41, 31104
    buffer_load_dwordx4 v9, s[8:11], s43 offen lds
    s_mul_i32 s44, s40, 8192
    s_add_u32 m0, s44, 4096
    s_add_u32 s43, s41, 41344
    buffer_load_dwordx4 v8, s[8:11], s43 offen lds
    s_mul_i32 s44, s40, 8192
    s_add_u32 m0, s44, 5120
    s_add_u32 s43, s41, 51584
    buffer_load_dwordx4 v9, s[8:11], s43 offen lds
    s_mul_i32 s44, s40, 8192
    s_add_u32 m0, s44, 6144
    s_add_u32 s43, s41, 61824
    buffer_load_dwordx4 v8, s[8:11], s43 offen lds
    s_mul_i32 s44, s40, 8192
    s_add_u32 m0, s44, 7168
    s_add_u32 s43, s41, 72064
    buffer_load_dwordx4 v9, s[8:11], s43 offen lds
    s_lshl_b32 s44, s40, 12
    s_add_u32 m0, s44, 32768
    s_mul_i32 s43, s26, 192
    s_add_u32 s43, s43, s42
    buffer_load_dwordx4 v10, s[12:15], s43 offen lds
    s_lshl_b32 s44, s40, 12
    s_add_u32 m0, s44, 33792
    s_mul_i32 s43, s26, 196
    s_add_u32 s43, s43, s42
    buffer_load_dwordx4 v10, s[12:15], s43 offen lds
    s_lshl_b32 s44, s40, 12
    s_add_u32 m0, s44, 34816
    s_mul_i32 s43, s26, 200
    s_add_u32 s43, s43, s42
    buffer_load_dwordx4 v10, s[12:15], s43 offen lds
    s_lshl_b32 s44, s40, 12
    s_add_u32 m0, s44, 35840
    s_mul_i32 s43, s26, 204
    s_add_u32 s43, s43, s42
    buffer_load_dwordx4 v10, s[12:15], s43 offen lds
    v_add_u32 v17, 49152, v11
    v_add_u32 v18, 49152, v12
    v_add_u32 v19, 49152, v13
    v_add_u32 v20, 49152, v14
    v_add_u32 v21, 49152, v15
    v_add_u32 v22, 49152, v16
    ds_read_b128 v[28:31], v17 offset:0
    ds_read_b128 v[32:35], v17 offset:4096
    ds_read_b128 v[36:39], v17 offset:8192
    ds_read_b128 v[40:43], v17 offset:12288
    ds_read_b64_tr_b16 v[60:61], v21 offset:0
    ds_read_b64_tr_b16 v[62:63], v21 offset:1024
    ds_read_b64_tr_b16 v[64:65], v22 offset:0
    ds_read_b64_tr_b16 v[66:67], v22 offset:1024
    v_mfma_f32_32x32x16_bf16 a[0:15], v[68:71], v[44:47], a[0:15]
    v_mfma_f32_32x32x16_bf16 a[16:31], v[72:75], v[44:47], a[16:31]
    v_mfma_f32_32x32x16_bf16 a[32:47], v[68:71], v[48:51], a[32:47]
    v_mfma_f32_32x32x16_bf16 a[48:63], v[72:75], v[48:51], a[48:63]
    v_mfma_f32_32x32x16_bf16 a[64:79], v[68:71], v[52:55], a[64:79]
    v_mfma_f32_32x32x16_bf16 a[80:95], v[72:75], v[52:55], a[80:95]
    v_mfma_f32_32x32x16_bf16 a[96:111], v[68:71], v[56:59], a[96:111]
    v_mfma_f32_32x32x16_bf16 a[112:127], v[72:75], v[56:59], a[112:127]
    ds_read_b128 v[44:47], v18 offset:0
    ds_read_b128 v[48:51], v18 offset:4096
    ds_read_b128 v[52:55], v18 offset:8192
    ds_read_b128 v[56:59], v18 offset:12288
    ds_read_b64_tr_b16 v[68:69], v21 offset:4096
    ds_read_b64_tr_b16 v[70:71], v21 offset:5120
    ds_read_b64_tr_b16 v[72:73], v22 offset:4096
    ds_read_b64_tr_b16 v[74:75], v22 offset:5120
    s_waitcnt lgkmcnt(8)
    v_mfma_f32_32x32x16_bf16 a[0:15], v[60:63], v[28:31], a[0:15]
    v_mfma_f32_32x32x16_bf16 a[16:31], v[64:67], v[28:31], a[16:31]
    v_mfma_f32_32x32x16_bf16 a[32:47], v[60:63], v[32:35], a[32:47]
    v_mfma_f32_32x32x16_bf16 a[48:63], v[64:67], v[32:35], a[48:63]
    v_mfma_f32_32x32x16_bf16 a[64:79], v[60:63], v[36:39], a[64:79]
    v_mfma_f32_32x32x16_bf16 a[80:95], v[64:67], v[36:39], a[80:95]
    v_mfma_f32_32x32x16_bf16 a[96:111], v[60:63], v[40:43], a[96:111]
    v_mfma_f32_32x32x16_bf16 a[112:127], v[64:67], v[40:43], a[112:127]
    ds_read_b128 v[28:31], v19 offset:0
    ds_read_b128 v[32:35], v19 offset:4096
    ds_read_b128 v[36:39], v19 offset:8192
    ds_read_b128 v[40:43], v19 offset:12288
    ds_read_b64_tr_b16 v[60:61], v21 offset:8192
    ds_read_b64_tr_b16 v[62:63], v21 offset:9216
    ds_read_b64_tr_b16 v[64:65], v22 offset:8192
    ds_read_b64_tr_b16 v[66:67], v22 offset:9216
    s_waitcnt lgkmcnt(8)
    v_mfma_f32_32x32x16_bf16 a[0:15], v[68:71], v[44:47], a[0:15]
    v_mfma_f32_32x32x16_bf16 a[16:31], v[72:75], v[44:47], a[16:31]
    v_mfma_f32_32x32x16_bf16 a[32:47], v[68:71], v[48:51], a[32:47]
    v_mfma_f32_32x32x16_bf16 a[48:63], v[72:75], v[48:51], a[48:63]
    v_mfma_f32_32x32x16_bf16 a[64:79], v[68:71], v[52:55], a[64:79]
    v_mfma_f32_32x32x16_bf16 a[80:95], v[72:75], v[52:55], a[80:95]
    v_mfma_f32_32x32x16_bf16 a[96:111], v[68:71], v[56:59], a[96:111]
    v_mfma_f32_32x32x16_bf16 a[112:127], v[72:75], v[56:59], a[112:127]
    ds_read_b128 v[44:47], v20 offset:0
    ds_read_b128 v[48:51], v20 offset:4096
    ds_read_b128 v[52:55], v20 offset:8192
    ds_read_b128 v[56:59], v20 offset:12288
    ds_read_b64_tr_b16 v[68:69], v21 offset:12288
    ds_read_b64_tr_b16 v[70:71], v21 offset:13312
    ds_read_b64_tr_b16 v[72:73], v22 offset:12288
    ds_read_b64_tr_b16 v[74:75], v22 offset:13312
    s_waitcnt lgkmcnt(8)
    v_mfma_f32_32x32x16_bf16 a[0:15], v[60:63], v[28:31], a[0:15]
    v_mfma_f32_32x32x16_bf16 a[16:31], v[64:67], v[28:31], a[16:31]
    v_mfma_f32_32x32x16_bf16 a[32:47], v[60:63], v[32:35], a[32:47]
    v_mfma_f32_32x32x16_bf16 a[48:63], v[64:67], v[32:35], a[48:63]
    v_mfma_f32_32x32x16_bf16 a[64:79], v[60:63], v[36:39], a[64:79]
    v_mfma_f32_32x32x16_bf16 a[80:95], v[64:67], v[36:39], a[80:95]
    v_mfma_f32_32x32x16_bf16 a[96:111], v[60:63], v[40:43], a[96:111]
    v_mfma_f32_32x32x16_bf16 a[112:127], v[64:67], v[40:43], a[112:127]
    s_waitcnt lgkmcnt(0)
    s_waitcnt vmcnt(12)
    s_barrier
    s_mul_i32 s44, s40, 8192
    s_add_u32 m0, s44, 49152
    s_add_u32 s43, s41, 512
    buffer_load_dwordx4 v8, s[8:11], s43 offen lds
    s_mul_i32 s44, s40, 8192
    s_add_u32 m0, s44, 50176
    s_add_u32 s43, s41, 10752
    buffer_load_dwordx4 v9, s[8:11], s43 offen lds
    s_mul_i32 s44, s40, 8192
    s_add_u32 m0, s44, 51200
    s_add_u32 s43, s41, 20992
    buffer_load_dwordx4 v8, s[8:11], s43 offen lds
    s_mul_i32 s44, s40, 8192
    s_add_u32 m0, s44, 52224
    s_add_u32 s43, s41, 31232
    buffer_load_dwordx4 v9, s[8:11], s43 offen lds
    s_mul_i32 s44, s40, 8192
    s_add_u32 m0, s44, 53248
    s_add_u32 s43, s41, 41472
    buffer_load_dwordx4 v8, s[8:11], s43 offen lds
    s_mul_i32 s44, s40, 8192
    s_add_u32 m0, s44, 54272
    s_add_u32 s43, s41, 51712
    buffer_load_dwordx4 v9, s[8:11], s43 offen lds
    s_mul_i32 s44, s40, 8192
    s_add_u32 m0, s44, 55296
    s_add_u32 s43, s41, 61952
    buffer_load_dwordx4 v8, s[8:11], s43 offen lds
    s_mul_i32 s44, s40, 8192
    s_add_u32 m0, s44, 56320
    s_add_u32 s43, s41, 72192
    buffer_load_dwordx4 v9, s[8:11], s43 offen lds
    s_lshl_b32 s44, s40, 12
    s_add_u32 m0, s44, 81920
    s_mul_i32 s43, s26, 256
    s_add_u32 s43, s43, s42
    buffer_load_dwordx4 v10, s[12:15], s43 offen lds
    s_lshl_b32 s44, s40, 12
    s_add_u32 m0, s44, 82944
    s_mul_i32 s43, s26, 260
    s_add_u32 s43, s43, s42
    buffer_load_dwordx4 v10, s[12:15], s43 offen lds
    s_lshl_b32 s44, s40, 12
    s_add_u32 m0, s44, 83968
    s_mul_i32 s43, s26, 264
    s_add_u32 s43, s43, s42
    buffer_load_dwordx4 v10, s[12:15], s43 offen lds
    s_lshl_b32 s44, s40, 12
    s_add_u32 m0, s44, 84992
    s_mul_i32 s43, s26, 268
    s_add_u32 s43, s43, s42
    buffer_load_dwordx4 v10, s[12:15], s43 offen lds
    v_add_u32 v17, 98304, v11
    v_add_u32 v18, 98304, v12
    v_add_u32 v19, 98304, v13
    v_add_u32 v20, 98304, v14
    v_add_u32 v21, 98304, v15
    v_add_u32 v22, 98304, v16
    ds_read_b128 v[28:31], v17 offset:0
    ds_read_b128 v[32:35], v17 offset:4096
    ds_read_b128 v[36:39], v17 offset:8192
    ds_read_b128 v[40:43], v17 offset:12288
    ds_read_b64_tr_b16 v[60:61], v21 offset:0
    ds_read_b64_tr_b16 v[62:63], v21 offset:1024
    ds_read_b64_tr_b16 v[64:65], v22 offset:0
    ds_read_b64_tr_b16 v[66:67], v22 offset:1024
    v_mfma_f32_32x32x16_bf16 a[0:15], v[68:71], v[44:47], a[0:15]
    v_mfma_f32_32x32x16_bf16 a[16:31], v[72:75], v[44:47], a[16:31]
    v_mfma_f32_32x32x16_bf16 a[32:47], v[68:71], v[48:51], a[32:47]
    v_mfma_f32_32x32x16_bf16 a[48:63], v[72:75], v[48:51], a[48:63]
    v_mfma_f32_32x32x16_bf16 a[64:79], v[68:71], v[52:55], a[64:79]
    v_mfma_f32_32x32x16_bf16 a[80:95], v[72:75], v[52:55], a[80:95]
    v_mfma_f32_32x32x16_bf16 a[96:111], v[68:71], v[56:59], a[96:111]
    v_mfma_f32_32x32x16_bf16 a[112:127], v[72:75], v[56:59], a[112:127]
    ds_read_b128 v[44:47], v18 offset:0
    ds_read_b128 v[48:51], v18 offset:4096
    ds_read_b128 v[52:55], v18 offset:8192
    ds_read_b128 v[56:59], v18 offset:12288
    ds_read_b64_tr_b16 v[68:69], v21 offset:4096
    ds_read_b64_tr_b16 v[70:71], v21 offset:5120
    ds_read_b64_tr_b16 v[72:73], v22 offset:4096
    ds_read_b64_tr_b16 v[74:75], v22 offset:5120
    s_waitcnt lgkmcnt(8)
    v_mfma_f32_32x32x16_bf16 a[0:15], v[60:63], v[28:31], a[0:15]
    v_mfma_f32_32x32x16_bf16 a[16:31], v[64:67], v[28:31], a[16:31]
    v_mfma_f32_32x32x16_bf16 a[32:47], v[60:63], v[32:35], a[32:47]
    v_mfma_f32_32x32x16_bf16 a[48:63], v[64:67], v[32:35], a[48:63]
    v_mfma_f32_32x32x16_bf16 a[64:79], v[60:63], v[36:39], a[64:79]
    v_mfma_f32_32x32x16_bf16 a[80:95], v[64:67], v[36:39], a[80:95]
    v_mfma_f32_32x32x16_bf16 a[96:111], v[60:63], v[40:43], a[96:111]
    v_mfma_f32_32x32x16_bf16 a[112:127], v[64:67], v[40:43], a[112:127]
    ds_read_b128 v[28:31], v19 offset:0
    ds_read_b128 v[32:35], v19 offset:4096
    ds_read_b128 v[36:39], v19 offset:8192
    ds_read_b128 v[40:43], v19 offset:12288
    ds_read_b64_tr_b16 v[60:61], v21 offset:8192
    ds_read_b64_tr_b16 v[62:63], v21 offset:9216
    ds_read_b64_tr_b16 v[64:65], v22 offset:8192
    ds_read_b64_tr_b16 v[66:67], v22 offset:9216
    s_waitcnt lgkmcnt(8)
    v_mfma_f32_32x32x16_bf16 a[0:15], v[68:71], v[44:47], a[0:15]
    v_mfma_f32_32x32x16_bf16 a[16:31], v[72:75], v[44:47], a[16:31]
    v_mfma_f32_32x32x16_bf16 a[32:47], v[68:71], v[48:51], a[32:47]
    v_mfma_f32_32x32x16_bf16 a[48:63], v[72:75], v[48:51], a[48:63]
    v_mfma_f32_32x32x16_bf16 a[64:79], v[68:71], v[52:55], a[64:79]
    v_mfma_f32_32x32x16_bf16 a[80:95], v[72:75], v[52:55], a[80:95]
    v_mfma_f32_32x32x16_bf16 a[96:111], v[68:71], v[56:59], a[96:111]
    v_mfma_f32_32x32x16_bf16 a[112:127], v[72:75], v[56:59], a[112:127]
    ds_read_b128 v[44:47], v20 offset:0
    ds_read_b128 v[48:51], v20 offset:4096
    ds_read_b128 v[52:55], v20 offset:8192
    ds_read_b128 v[56:59], v20 offset:12288
    ds_read_b64_tr_b16 v[68:69], v21 offset:12288
    ds_read_b64_tr_b16 v[70:71], v21 offset:13312
    ds_read_b64_tr_b16 v[72:73], v22 offset:12288
    ds_read_b64_tr_b16 v[74:75], v22 offset:13312
    s_waitcnt lgkmcnt(8)
    v_mfma_f32_32x32x16_bf16 a[0:15], v[60:63], v[28:31], a[0:15]
    v_mfma_f32_32x32x16_bf16 a[16:31], v[64:67], v[28:31], a[16:31]
    v_mfma_f32_32x32x16_bf16 a[32:47], v[60:63], v[32:35], a[32:47]
    v_mfma_f32_32x32x16_bf16 a[48:63], v[64:67], v[32:35], a[48:63]
    v_mfma_f32_32x32x16_bf16 a[64:79], v[60:63], v[36:39], a[64:79]
    v_mfma_f32_32x32x16_bf16 a[80:95], v[64:67], v[36:39], a[80:95]
    v_mfma_f32_32x32x16_bf16 a[96:111], v[60:63], v[40:43], a[96:111]
    v_mfma_f32_32x32x16_bf16 a[112:127], v[64:67], v[40:43], a[112:127]
    s_waitcnt lgkmcnt(0)
    s_waitcnt vmcnt(12)
    s_barrier
    s_mul_i32 s44, s40, 8192
    s_add_u32 m0, s44, 98304
    s_add_u32 s43, s41, 640
    buffer_load_dwordx4 v8, s[8:11], s43 offen lds
    s_mul_i32 s44, s40, 8192
    s_add_u32 m0, s44, 99328
    s_add_u32 s43, s41, 10880
    buffer_load_dwordx4 v9, s[8:11], s43 offen lds
    s_mul_i32 s44, s40, 8192
    s_add_u32 m0, s44, 100352
    s_add_u32 s43, s41, 21120
    buffer_load_dwordx4 v8, s[8:11], s43 offen lds
    s_mul_i32 s44, s40, 8192
    s_add_u32 m0, s44, 101376
    s_add_u32 s43, s41, 31360
    buffer_load_dwordx4 v9, s[8:11], s43 offen lds
    s_mul_i32 s44, s40, 8192
    s_add_u32 m0, s44, 102400
    s_add_u32 s43, s41, 41600
    buffer_load_dwordx4 v8, s[8:11], s43 offen lds
    s_mul_i32 s44, s40, 8192
    s_add_u32 m0, s44, 103424
    s_add_u32 s43, s41, 51840
    buffer_load_dwordx4 v9, s[8:11], s43 offen lds
    s_mul_i32 s44, s40, 8192
    s_add_u32 m0, s44, 104448
    s_add_u32 s43, s41, 62080
    buffer_load_dwordx4 v8, s[8:11], s43 offen lds
    s_mul_i32 s44, s40, 8192
    s_add_u32 m0, s44, 105472
    s_add_u32 s43, s41, 72320
    buffer_load_dwordx4 v9, s[8:11], s43 offen lds
    s_lshl_b32 s44, s40, 12
    s_add_u32 m0, s44, 131072
    s_mul_i32 s43, s26, 320
    s_add_u32 s43, s43, s42
    buffer_load_dwordx4 v10, s[12:15], s43 offen lds
    s_lshl_b32 s44, s40, 12
    s_add_u32 m0, s44, 132096
    s_mul_i32 s43, s26, 324
    s_add_u32 s43, s43, s42
    buffer_load_dwordx4 v10, s[12:15], s43 offen lds
    s_lshl_b32 s44, s40, 12
    s_add_u32 m0, s44, 133120
    s_mul_i32 s43, s26, 328
    s_add_u32 s43, s43, s42
    buffer_load_dwordx4 v10, s[12:15], s43 offen lds
    s_lshl_b32 s44, s40, 12
    s_add_u32 m0, s44, 134144
    s_mul_i32 s43, s26, 332
    s_add_u32 s43, s43, s42
    buffer_load_dwordx4 v10, s[12:15], s43 offen lds
    v_add_u32 v17, 0, v11
    v_add_u32 v18, 0, v12
    v_add_u32 v19, 0, v13
    v_add_u32 v20, 0, v14
    v_add_u32 v21, 0, v15
    v_add_u32 v22, 0, v16
    ds_read_b128 v[28:31], v17 offset:0
    ds_read_b128 v[32:35], v17 offset:4096
    ds_read_b128 v[36:39], v17 offset:8192
    ds_read_b128 v[40:43], v17 offset:12288
    ds_read_b64_tr_b16 v[60:61], v21 offset:0
    ds_read_b64_tr_b16 v[62:63], v21 offset:1024
    ds_read_b64_tr_b16 v[64:65], v22 offset:0
    ds_read_b64_tr_b16 v[66:67], v22 offset:1024
    v_mfma_f32_32x32x16_bf16 a[0:15], v[68:71], v[44:47], a[0:15]
    v_mfma_f32_32x32x16_bf16 a[16:31], v[72:75], v[44:47], a[16:31]
    v_mfma_f32_32x32x16_bf16 a[32:47], v[68:71], v[48:51], a[32:47]
    v_mfma_f32_32x32x16_bf16 a[48:63], v[72:75], v[48:51], a[48:63]
    v_mfma_f32_32x32x16_bf16 a[64:79], v[68:71], v[52:55], a[64:79]
    v_mfma_f32_32x32x16_bf16 a[80:95], v[72:75], v[52:55], a[80:95]
    v_mfma_f32_32x32x16_bf16 a[96:111], v[68:71], v[56:59], a[96:111]
    v_mfma_f32_32x32x16_bf16 a[112:127], v[72:75], v[56:59], a[112:127]
    ds_read_b128 v[44:47], v18 offset:0
    ds_read_b128 v[48:51], v18 offset:4096
    ds_read_b128 v[52:55], v18 offset:8192
    ds_read_b128 v[56:59], v18 offset:12288
    ds_read_b64_tr_b16 v[68:69], v21 offset:4096
    ds_read_b64_tr_b16 v[70:71], v21 offset:5120
    ds_read_b64_tr_b16 v[72:73], v22 offset:4096
    ds_read_b64_tr_b16 v[74:75], v22 offset:5120
    s_waitcnt lgkmcnt(8)
    v_mfma_f32_32x32x16_bf16 a[0:15], v[60:63], v[28:31], a[0:15]
    v_mfma_f32_32x32x16_bf16 a[16:31], v[64:67], v[28:31], a[16:31]
    v_mfma_f32_32x32x16_bf16 a[32:47], v[60:63], v[32:35], a[32:47]
    v_mfma_f32_32x32x16_bf16 a[48:63], v[64:67], v[32:35], a[48:63]
    v_mfma_f32_32x32x16_bf16 a[64:79], v[60:63], v[36:39], a[64:79]
    v_mfma_f32_32x32x16_bf16 a[80:95], v[64:67], v[36:39], a[80:95]
    v_mfma_f32_32x32x16_bf16 a[96:111], v[60:63], v[40:43], a[96:111]
    v_mfma_f32_32x32x16_bf16 a[112:127], v[64:67], v[40:43], a[112:127]
    ds_read_b128 v[28:31], v19 offset:0
    ds_read_b128 v[32:35], v19 offset:4096
    ds_read_b128 v[36:39], v19 offset:8192
    ds_read_b128 v[40:43], v19 offset:12288
    ds_read_b64_tr_b16 v[60:61], v21 offset:8192
    ds_read_b64_tr_b16 v[62:63], v21 offset:9216
    ds_read_b64_tr_b16 v[64:65], v22 offset:8192
    ds_read_b64_tr_b16 v[66:67], v22 offset:9216
    s_waitcnt lgkmcnt(8)
    v_mfma_f32_32x32x16_bf16 a[0:15], v[68:71], v[44:47], a[0:15]
    v_mfma_f32_32x32x16_bf16 a[16:31], v[72:75], v[44:47], a[16:31]
    v_mfma_f32_32x32x16_bf16 a[32:47], v[68:71], v[48:51], a[32:47]
    v_mfma_f32_32x32x16_bf16 a[48:63], v[72:75], v[48:51], a[48:63]
    v_mfma_f32_32x32x16_bf16 a[64:79], v[68:71], v[52:55], a[64:79]
    v_mfma_f32_32x32x16_bf16 a[80:95], v[72:75], v[52:55], a[80:95]
    v_mfma_f32_32x32x16_bf16 a[96:111], v[68:71], v[56:59], a[96:111]
    v_mfma_f32_32x32x16_bf16 a[112:127], v[72:75], v[56:59], a[112:127]
    ds_read_b128 v[44:47], v20 offset:0
    ds_read_b128 v[48:51], v20 offset:4096
    ds_read_b128 v[52:55], v20 offset:8192
    ds_read_b128 v[56:59], v20 offset:12288
    ds_read_b64_tr_b16 v[68:69], v21 offset:12288
    ds_read_b64_tr_b16 v[70:71], v21 offset:13312
    ds_read_b64_tr_b16 v[72:73], v22 offset:12288
    ds_read_b64_tr_b16 v[74:75], v22 offset:13312
    s_waitcnt lgkmcnt(8)
    v_mfma_f32_32x32x16_bf16 a[0:15], v[60:63], v[28:31], a[0:15]
    v_mfma_f32_32x32x16_bf16 a[16:31], v[64:67], v[28:31], a[16:31]
    v_mfma_f32_32x32x16_bf16 a[32:47], v[60:63], v[32:35], a[32:47]
    v_mfma_f32_32x32x16_bf16 a[48:63], v[64:67], v[32:35], a[48:63]
    v_mfma_f32_32x32x16_bf16 a[64:79], v[60:63], v[36:39], a[64:79]
    v_mfma_f32_32x32x16_bf16 a[80:95], v[64:67], v[36:39], a[80:95]
    v_mfma_f32_32x32x16_bf16 a[96:111], v[60:63], v[40:43], a[96:111]
    v_mfma_f32_32x32x16_bf16 a[112:127], v[64:67], v[40:43], a[112:127]
    s_waitcnt lgkmcnt(0)
    s_waitcnt vmcnt(12)
    s_barrier
    s_mul_i32 s44, s40, 8192
    s_add_u32 m0, s44, 0
    s_add_u32 s43, s41, 768
    buffer_load_dwordx4 v8, s[8:11], s43 offen lds
    s_mul_i32 s44, s40, 8192
    s_add_u32 m0, s44, 1024
    s_add_u32 s43, s41, 11008
    buffer_load_dwordx4 v9, s[8:11], s43 offen lds
    s_mul_i32 s44, s40, 8192
    s_add_u32 m0, s44, 2048
    s_add_u32 s43, s41, 21248
    buffer_load_dwordx4 v8, s[8:11], s43 offen lds
    s_mul_i32 s44, s40, 8192
    s_add_u32 m0, s44, 3072
    s_add_u32 s43, s41, 31488
    buffer_load_dwordx4 v9, s[8:11], s43 offen lds
    s_mul_i32 s44, s40, 8192
    s_add_u32 m0, s44, 4096
    s_add_u32 s43, s41, 41728
    buffer_load_dwordx4 v8, s[8:11], s43 offen lds
    s_mul_i32 s44, s40, 8192
    s_add_u32 m0, s44, 5120
    s_add_u32 s43, s41, 51968
    buffer_load_dwordx4 v9, s[8:11], s43 offen lds
    s_mul_i32 s44, s40, 8192
    s_add_u32 m0, s44, 6144
    s_add_u32 s43, s41, 62208
    buffer_load_dwordx4 v8, s[8:11], s43 offen lds
    s_mul_i32 s44, s40, 8192
    s_add_u32 m0, s44, 7168
    s_add_u32 s43, s41, 72448
    buffer_load_dwordx4 v9, s[8:11], s43 offen lds
    s_lshl_b32 s44, s40, 12
    s_add_u32 m0, s44, 32768
    s_mul_i32 s43, s26, 384
    s_add_u32 s43, s43, s42
    buffer_load_dwordx4 v10, s[12:15], s43 offen lds
    s_lshl_b32 s44, s40, 12
    s_add_u32 m0, s44, 33792
    s_mul_i32 s43, s26, 388
    s_add_u32 s43, s43, s42
    buffer_load_dwordx4 v10, s[12:15], s43 offen lds
    s_lshl_b32 s44, s40, 12
    s_add_u32 m0, s44, 34816
    s_mul_i32 s43, s26, 392
    s_add_u32 s43, s43, s42
    buffer_load_dwordx4 v10, s[12:15], s43 offen lds
    s_lshl_b32 s44, s40, 12
    s_add_u32 m0, s44, 35840
    s_mul_i32 s43, s26, 396
    s_add_u32 s43, s43, s42
    buffer_load_dwordx4 v10, s[12:15], s43 offen lds
    v_add_u32 v17, 49152, v11
    v_add_u32 v18, 49152, v12
    v_add_u32 v19, 49152, v13
    v_add_u32 v20, 49152, v14
    v_add_u32 v21, 49152, v15
    v_add_u32 v22, 49152, v16
    ds_read_b128 v[28:31], v17 offset:0
    ds_read_b128 v[32:35], v17 offset:4096
    ds_read_b128 v[36:39], v17 offset:8192
    ds_read_b128 v[40:43], v17 offset:12288
    ds_read_b64_tr_b16 v[60:61], v21 offset:0
    ds_read_b64_tr_b16 v[62:63], v21 offset:1024
    ds_read_b64_tr_b16 v[64:65], v22 offset:0
    ds_read_b64_tr_b16 v[66:67], v22 offset:1024
    v_mfma_f32_32x32x16_bf16 a[0:15], v[68:71], v[44:47], a[0:15]
    v_mfma_f32_32x32x16_bf16 a[16:31], v[72:75], v[44:47], a[16:31]
    v_mfma_f32_32x32x16_bf16 a[32:47], v[68:71], v[48:51], a[32:47]
    v_mfma_f32_32x32x16_bf16 a[48:63], v[72:75], v[48:51], a[48:63]
    v_mfma_f32_32x32x16_bf16 a[64:79], v[68:71], v[52:55], a[64:79]
    v_mfma_f32_32x32x16_bf16 a[80:95], v[72:75], v[52:55], a[80:95]
    v_mfma_f32_32x32x16_bf16 a[96:111], v[68:71], v[56:59], a[96:111]
    v_mfma_f32_32x32x16_bf16 a[112:127], v[72:75], v[56:59], a[112:127]
    ds_read_b128 v[44:47], v18 offset:0
    ds_read_b128 v[48:51], v18 offset:4096
    ds_read_b128 v[52:55], v18 offset:8192
    ds_read_b128 v[56:59], v18 offset:12288
    ds_read_b64_tr_b16 v[68:69], v21 offset:4096
    ds_read_b64_tr_b16 v[70:71], v21 offset:5120
    ds_read_b64_tr_b16 v[72:73], v22 offset:4096
    ds_read_b64_tr_b16 v[74:75], v22 offset:5120
    s_waitcnt lgkmcnt(8)
    v_mfma_f32_32x32x16_bf16 a[0:15], v[60:63], v[28:31], a[0:15]
    v_mfma_f32_32x32x16_bf16 a[16:31], v[64:67], v[28:31], a[16:31]
    v_mfma_f32_32x32x16_bf16 a[32:47], v[60:63], v[32:35], a[32:47]
    v_mfma_f32_32x32x16_bf16 a[48:63], v[64:67], v[32:35], a[48:63]
    v_mfma_f32_32x32x16_bf16 a[64:79], v[60:63], v[36:39], a[64:79]
    v_mfma_f32_32x32x16_bf16 a[80:95], v[64:67], v[36:39], a[80:95]
    v_mfma_f32_32x32x16_bf16 a[96:111], v[60:63], v[40:43], a[96:111]
    v_mfma_f32_32x32x16_bf16 a[112:127], v[64:67], v[40:43], a[112:127]
    ds_read_b128 v[28:31], v19 offset:0
    ds_read_b128 v[32:35], v19 offset:4096
    ds_read_b128 v[36:39], v19 offset:8192
    ds_read_b128 v[40:43], v19 offset:12288
    ds_read_b64_tr_b16 v[60:61], v21 offset:8192
    ds_read_b64_tr_b16 v[62:63], v21 offset:9216
    ds_read_b64_tr_b16 v[64:65], v22 offset:8192
    ds_read_b64_tr_b16 v[66:67], v22 offset:9216
    s_waitcnt lgkmcnt(8)
    v_mfma_f32_32x32x16_bf16 a[0:15], v[68:71], v[44:47], a[0:15]
    v_mfma_f32_32x32x16_bf16 a[16:31], v[72:75], v[44:47], a[16:31]
    v_mfma_f32_32x32x16_bf16 a[32:47], v[68:71], v[48:51], a[32:47]
    v_mfma_f32_32x32x16_bf16 a[48:63], v[72:75], v[48:51], a[48:63]
    v_mfma_f32_32x32x16_bf16 a[64:79], v[68:71], v[52:55], a[64:79]
    v_mfma_f32_32x32x16_bf16 a[80:95], v[72:75], v[52:55], a[80:95]
    v_mfma_f32_32x32x16_bf16 a[96:111], v[68:71], v[56:59], a[96:111]
    v_mfma_f32_32x32x16_bf16 a[112:127], v[72:75], v[56:59], a[112:127]
    ds_read_b128 v[44:47], v20 offset:0
    ds_read_b128 v[48:51], v20 offset:4096
    ds_read_b128 v[52:55], v20 offset:8192
    ds_read_b128 v[56:59], v20 offset:12288
    ds_read_b64_tr_b16 v[68:69], v21 offset:12288
    ds_read_b64_tr_b16 v[70:71], v21 offset:13312
    ds_read_b64_tr_b16 v[72:73], v22 offset:12288
    ds_read_b64_tr_b16 v[74:75], v22 offset:13312
    s_waitcnt lgkmcnt(8)
    v_mfma_f32_32x32x16_bf16 a[0:15], v[60:63], v[28:31], a[0:15]
    v_mfma_f32_32x32x16_bf16 a[16:31], v[64:67], v[28:31], a[16:31]
    v_mfma_f32_32x32x16_bf16 a[32:47], v[60:63], v[32:35], a[32:47]
    v_mfma_f32_32x32x16_bf16 a[48:63], v[64:67], v[32:35], a[48:63]
    v_mfma_f32_32x32x16_bf16 a[64:79], v[60:63], v[36:39], a[64:79]
    v_mfma_f32_32x32x16_bf16 a[80:95], v[64:67], v[36:39], a[80:95]
    v_mfma_f32_32x32x16_bf16 a[96:111], v[60:63], v[40:43], a[96:111]
    v_mfma_f32_32x32x16_bf16 a[112:127], v[64:67], v[40:43], a[112:127]
    s_waitcnt lgkmcnt(0)
    s_waitcnt vmcnt(12)
    s_barrier
    s_mul_i32 s44, s40, 8192
    s_add_u32 m0, s44, 49152
    s_add_u32 s43, s41, 896
    buffer_load_dwordx4 v8, s[8:11], s43 offen lds
    s_mul_i32 s44, s40, 8192
    s_add_u32 m0, s44, 50176
    s_add_u32 s43, s41, 11136
    buffer_load_dwordx4 v9, s[8:11], s43 offen lds
    s_mul_i32 s44, s40, 8192
    s_add_u32 m0, s44, 51200
    s_add_u32 s43, s41, 21376
    buffer_load_dwordx4 v8, s[8:11], s43 offen lds
    s_mul_i32 s44, s40, 8192
    s_add_u32 m0, s44, 52224
    s_add_u32 s43, s41, 31616
    buffer_load_dwordx4 v9, s[8:11], s43 offen lds
    s_mul_i32 s44, s40, 8192
    s_add_u32 m0, s44, 53248
    s_add_u32 s43, s41, 41856
    buffer_load_dwordx4 v8, s[8:11], s43 offen lds
    s_mul_i32 s44, s40, 8192
    s_add_u32 m0, s44, 54272
    s_add_u32 s43, s41, 52096
    buffer_load_dwordx4 v9, s[8:11], s43 offen lds
    s_mul_i32 s44, s40, 8192
    s_add_u32 m0, s44, 55296
    s_add_u32 s43, s41, 62336
    buffer_load_dwordx4 v8, s[8:11], s43 offen lds
    s_mul_i32 s44, s40, 8192
    s_add_u32 m0, s44, 56320
    s_add_u32 s43, s41, 72576
    buffer_load_dwordx4 v9, s[8:11], s43 offen lds
    s_lshl_b32 s44, s40, 12
    s_add_u32 m0, s44, 81920
    s_mul_i32 s43, s26, 448
    s_add_u32 s43, s43, s42
    buffer_load_dwordx4 v10, s[12:15], s43 offen lds
    s_lshl_b32 s44, s40, 12
    s_add_u32 m0, s44, 82944
    s_mul_i32 s43, s26, 452
    s_add_u32 s43, s43, s42
    buffer_load_dwordx4 v10, s[12:15], s43 offen lds
    s_lshl_b32 s44, s40, 12
    s_add_u32 m0, s44, 83968
    s_mul_i32 s43, s26, 456
    s_add_u32 s43, s43, s42
    buffer_load_dwordx4 v10, s[12:15], s43 offen lds
    s_lshl_b32 s44, s40, 12
    s_add_u32 m0, s44, 84992
    s_mul_i32 s43, s26, 460
    s_add_u32 s43, s43, s42
    buffer_load_dwordx4 v10, s[12:15], s43 offen lds
    v_add_u32 v17, 98304, v11
    v_add_u32 v18, 98304, v12
    v_add_u32 v19, 98304, v13
    v_add_u32 v20, 98304, v14
    v_add_u32 v21, 98304, v15
    v_add_u32 v22, 98304, v16
    ds_read_b128 v[28:31], v17 offset:0
    ds_read_b128 v[32:35], v17 offset:4096
    ds_read_b128 v[36:39], v17 offset:8192
    ds_read_b128 v[40:43], v17 offset:12288
    ds_read_b64_tr_b16 v[60:61], v21 offset:0
    ds_read_b64_tr_b16 v[62:63], v21 offset:1024
    ds_read_b64_tr_b16 v[64:65], v22 offset:0
    ds_read_b64_tr_b16 v[66:67], v22 offset:1024
    v_mfma_f32_32x32x16_bf16 a[0:15], v[68:71], v[44:47], a[0:15]
    v_mfma_f32_32x32x16_bf16 a[16:31], v[72:75], v[44:47], a[16:31]
    v_mfma_f32_32x32x16_bf16 a[32:47], v[68:71], v[48:51], a[32:47]
    v_mfma_f32_32x32x16_bf16 a[48:63], v[72:75], v[48:51], a[48:63]
    v_mfma_f32_32x32x16_bf16 a[64:79], v[68:71], v[52:55], a[64:79]
    v_mfma_f32_32x32x16_bf16 a[80:95], v[72:75], v[52:55], a[80:95]
    v_mfma_f32_32x32x16_bf16 a[96:111], v[68:71], v[56:59], a[96:111]
    v_mfma_f32_32x32x16_bf16 a[112:127], v[72:75], v[56:59], a[112:127]
    ds_read_b128 v[44:47], v18 offset:0
    ds_read_b128 v[48:51], v18 offset:4096
    ds_read_b128 v[52:55], v18 offset:8192
    ds_read_b128 v[56:59], v18 offset:12288
    ds_read_b64_tr_b16 v[68:69], v21 offset:4096
    ds_read_b64_tr_b16 v[70:71], v21 offset:5120
    ds_read_b64_tr_b16 v[72:73], v22 offset:4096
    ds_read_b64_tr_b16 v[74:75], v22 offset:5120
    s_waitcnt lgkmcnt(8)
    v_mfma_f32_32x32x16_bf16 a[0:15], v[60:63], v[28:31], a[0:15]
    v_mfma_f32_32x32x16_bf16 a[16:31], v[64:67], v[28:31], a[16:31]
    v_mfma_f32_32x32x16_bf16 a[32:47], v[60:63], v[32:35], a[32:47]
    v_mfma_f32_32x32x16_bf16 a[48:63], v[64:67], v[32:35], a[48:63]
    v_mfma_f32_32x32x16_bf16 a[64:79], v[60:63], v[36:39], a[64:79]
    v_mfma_f32_32x32x16_bf16 a[80:95], v[64:67], v[36:39], a[80:95]
    v_mfma_f32_32x32x16_bf16 a[96:111], v[60:63], v[40:43], a[96:111]
    v_mfma_f32_32x32x16_bf16 a[112:127], v[64:67], v[40:43], a[112:127]
    ds_read_b128 v[28:31], v19 offset:0
    ds_read_b128 v[32:35], v19 offset:4096
    ds_read_b128 v[36:39], v19 offset:8192
    ds_read_b128 v[40:43], v19 offset:12288
    ds_read_b64_tr_b16 v[60:61], v21 offset:8192
    ds_read_b64_tr_b16 v[62:63], v21 offset:9216
    ds_read_b64_tr_b16 v[64:65], v22 offset:8192
    ds_read_b64_tr_b16 v[66:67], v22 offset:9216
    s_waitcnt lgkmcnt(8)
    v_mfma_f32_32x32x16_bf16 a[0:15], v[68:71], v[44:47], a[0:15]
    v_mfma_f32_32x32x16_bf16 a[16:31], v[72:75], v[44:47], a[16:31]
    v_mfma_f32_32x32x16_bf16 a[32:47], v[68:71], v[48:51], a[32:47]
    v_mfma_f32_32x32x16_bf16 a[48:63], v[72:75], v[48:51], a[48:63]
    v_mfma_f32_32x32x16_bf16 a[64:79], v[68:71], v[52:55], a[64:79]
    v_mfma_f32_32x32x16_bf16 a[80:95], v[72:75], v[52:55], a[80:95]
    v_mfma_f32_32x32x16_bf16 a[96:111], v[68:71], v[56:59], a[96:111]
    v_mfma_f32_32x32x16_bf16 a[112:127], v[72:75], v[56:59], a[112:127]
    ds_read_b128 v[44:47], v20 offset:0
    ds_read_b128 v[48:51], v20 offset:4096
    ds_read_b128 v[52:55], v20 offset:8192
    ds_read_b128 v[56:59], v20 offset:12288
    ds_read_b64_tr_b16 v[68:69], v21 offset:12288
    ds_read_b64_tr_b16 v[70:71], v21 offset:13312
    ds_read_b64_tr_b16 v[72:73], v22 offset:12288
    ds_read_b64_tr_b16 v[74:75], v22 offset:13312
    s_waitcnt lgkmcnt(8)
    v_mfma_f32_32x32x16_bf16 a[0:15], v[60:63], v[28:31], a[0:15]
    v_mfma_f32_32x32x16_bf16 a[16:31], v[64:67], v[28:31], a[16:31]
    v_mfma_f32_32x32x16_bf16 a[32:47], v[60:63], v[32:35], a[32:47]
    v_mfma_f32_32x32x16_bf16 a[48:63], v[64:67], v[32:35], a[48:63]
    v_mfma_f32_32x32x16_bf16 a[64:79], v[60:63], v[36:39], a[64:79]
    v_mfma_f32_32x32x16_bf16 a[80:95], v[64:67], v[36:39], a[80:95]
    v_mfma_f32_32x32x16_bf16 a[96:111], v[60:63], v[40:43], a[96:111]
    v_mfma_f32_32x32x16_bf16 a[112:127], v[64:67], v[40:43], a[112:127]
    s_waitcnt lgkmcnt(0)
    s_waitcnt vmcnt(12)
    s_barrier
    s_mul_i32 s44, s40, 8192
    s_add_u32 m0, s44, 98304
    s_add_u32 s43, s41, 1024
    buffer_load_dwordx4 v8, s[8:11], s43 offen lds
    s_mul_i32 s44, s40, 8192
    s_add_u32 m0, s44, 99328
    s_add_u32 s43, s41, 11264
    buffer_load_dwordx4 v9, s[8:11], s43 offen lds
    s_mul_i32 s44, s40, 8192
    s_add_u32 m0, s44, 100352
    s_add_u32 s43, s41, 21504
    buffer_load_dwordx4 v8, s[8:11], s43 offen lds
    s_mul_i32 s44, s40, 8192
    s_add_u32 m0, s44, 101376
    s_add_u32 s43, s41, 31744
    buffer_load_dwordx4 v9, s[8:11], s43 offen lds
    s_mul_i32 s44, s40, 8192
    s_add_u32 m0, s44, 102400
    s_add_u32 s43, s41, 41984
    buffer_load_dwordx4 v8, s[8:11], s43 offen lds
    s_mul_i32 s44, s40, 8192
    s_add_u32 m0, s44, 103424
    s_add_u32 s43, s41, 52224
    buffer_load_dwordx4 v9, s[8:11], s43 offen lds
    s_mul_i32 s44, s40, 8192
    s_add_u32 m0, s44, 104448
    s_add_u32 s43, s41, 62464
    buffer_load_dwordx4 v8, s[8:11], s43 offen lds
    s_mul_i32 s44, s40, 8192
    s_add_u32 m0, s44, 105472
    s_add_u32 s43, s41, 72704
    buffer_load_dwordx4 v9, s[8:11], s43 offen lds
    s_lshl_b32 s44, s40, 12
    s_add_u32 m0, s44, 131072
    s_mul_i32 s43, s26, 512
    s_add_u32 s43, s43, s42
    buffer_load_dwordx4 v10, s[12:15], s43 offen lds
    s_lshl_b32 s44, s40, 12
    s_add_u32 m0, s44, 132096
    s_mul_i32 s43, s26, 516
    s_add_u32 s43, s43, s42
    buffer_load_dwordx4 v10, s[12:15], s43 offen lds
    s_lshl_b32 s44, s40, 12
    s_add_u32 m0, s44, 133120
    s_mul_i32 s43, s26, 520
    s_add_u32 s43, s43, s42
    buffer_load_dwordx4 v10, s[12:15], s43 offen lds
    s_lshl_b32 s44, s40, 12
    s_add_u32 m0, s44, 134144
    s_mul_i32 s43, s26, 524
    s_add_u32 s43, s43, s42
    buffer_load_dwordx4 v10, s[12:15], s43 offen lds
    v_add_u32 v17, 0, v11
    v_add_u32 v18, 0, v12
    v_add_u32 v19, 0, v13
    v_add_u32 v20, 0, v14
    v_add_u32 v21, 0, v15
    v_add_u32 v22, 0, v16
    ds_read_b128 v[28:31], v17 offset:0
    ds_read_b128 v[32:35], v17 offset:4096
    ds_read_b128 v[36:39], v17 offset:8192
    ds_read_b128 v[40:43], v17 offset:12288
    ds_read_b64_tr_b16 v[60:61], v21 offset:0
    ds_read_b64_tr_b16 v[62:63], v21 offset:1024
    ds_read_b64_tr_b16 v[64:65], v22 offset:0
    ds_read_b64_tr_b16 v[66:67], v22 offset:1024
    v_mfma_f32_32x32x16_bf16 a[0:15], v[68:71], v[44:47], a[0:15]
    v_mfma_f32_32x32x16_bf16 a[16:31], v[72:75], v[44:47], a[16:31]
    v_mfma_f32_32x32x16_bf16 a[32:47], v[68:71], v[48:51], a[32:47]
    v_mfma_f32_32x32x16_bf16 a[48:63], v[72:75], v[48:51], a[48:63]
    v_mfma_f32_32x32x16_bf16 a[64:79], v[68:71], v[52:55], a[64:79]
    v_mfma_f32_32x32x16_bf16 a[80:95], v[72:75], v[52:55], a[80:95]
    v_mfma_f32_32x32x16_bf16 a[96:111], v[68:71], v[56:59], a[96:111]
    v_mfma_f32_32x32x16_bf16 a[112:127], v[72:75], v[56:59], a[112:127]
    ds_read_b128 v[44:47], v18 offset:0
    ds_read_b128 v[48:51], v18 offset:4096
    ds_read_b128 v[52:55], v18 offset:8192
    ds_read_b128 v[56:59], v18 offset:12288
    ds_read_b64_tr_b16 v[68:69], v21 offset:4096
    ds_read_b64_tr_b16 v[70:71], v21 offset:5120
    ds_read_b64_tr_b16 v[72:73], v22 offset:4096
    ds_read_b64_tr_b16 v[74:75], v22 offset:5120
    s_waitcnt lgkmcnt(8)
    v_mfma_f32_32x32x16_bf16 a[0:15], v[60:63], v[28:31], a[0:15]
    v_mfma_f32_32x32x16_bf16 a[16:31], v[64:67], v[28:31], a[16:31]
    v_mfma_f32_32x32x16_bf16 a[32:47], v[60:63], v[32:35], a[32:47]
    v_mfma_f32_32x32x16_bf16 a[48:63], v[64:67], v[32:35], a[48:63]
    v_mfma_f32_32x32x16_bf16 a[64:79], v[60:63], v[36:39], a[64:79]
    v_mfma_f32_32x32x16_bf16 a[80:95], v[64:67], v[36:39], a[80:95]
    v_mfma_f32_32x32x16_bf16 a[96:111], v[60:63], v[40:43], a[96:111]
    v_mfma_f32_32x32x16_bf16 a[112:127], v[64:67], v[40:43], a[112:127]
    ds_read_b128 v[28:31], v19 offset:0
    ds_read_b128 v[32:35], v19 offset:4096
    ds_read_b128 v[36:39], v19 offset:8192
    ds_read_b128 v[40:43], v19 offset:12288
    ds_read_b64_tr_b16 v[60:61], v21 offset:8192
    ds_read_b64_tr_b16 v[62:63], v21 offset:9216
    ds_read_b64_tr_b16 v[64:65], v22 offset:8192
    ds_read_b64_tr_b16 v[66:67], v22 offset:9216
    s_waitcnt lgkmcnt(8)
    v_mfma_f32_32x32x16_bf16 a[0:15], v[68:71], v[44:47], a[0:15]
    v_mfma_f32_32x32x16_bf16 a[16:31], v[72:75], v[44:47], a[16:31]
    v_mfma_f32_32x32x16_bf16 a[32:47], v[68:71], v[48:51], a[32:47]
    v_mfma_f32_32x32x16_bf16 a[48:63], v[72:75], v[48:51], a[48:63]
    v_mfma_f32_32x32x16_bf16 a[64:79], v[68:71], v[52:55], a[64:79]
    v_mfma_f32_32x32x16_bf16 a[80:95], v[72:75], v[52:55], a[80:95]
    v_mfma_f32_32x32x16_bf16 a[96:111], v[68:71], v[56:59], a[96:111]
    v_mfma_f32_32x32x16_bf16 a[112:127], v[72:75], v[56:59], a[112:127]
    ds_read_b128 v[44:47], v20 offset:0
    ds_read_b128 v[48:51], v20 offset:4096
    ds_read_b128 v[52:55], v20 offset:8192
    ds_read_b128 v[56:59], v20 offset:12288
    ds_read_b64_tr_b16 v[68:69], v21 offset:12288
    ds_read_b64_tr_b16 v[70:71], v21 offset:13312
    ds_read_b64_tr_b16 v[72:73], v22 offset:12288
    ds_read_b64_tr_b16 v[74:75], v22 offset:13312
    s_waitcnt lgkmcnt(8)
    v_mfma_f32_32x32x16_bf16 a[0:15], v[60:63], v[28:31], a[0:15]
    v_mfma_f32_32x32x16_bf16 a[16:31], v[64:67], v[28:31], a[16:31]
    v_mfma_f32_32x32x16_bf16 a[32:47], v[60:63], v[32:35], a[32:47]
    v_mfma_f32_32x32x16_bf16 a[48:63], v[64:67], v[32:35], a[48:63]
    v_mfma_f32_32x32x16_bf16 a[64:79], v[60:63], v[36:39], a[64:79]
    v_mfma_f32_32x32x16_bf16 a[80:95], v[64:67], v[36:39], a[80:95]
    v_mfma_f32_32x32x16_bf16 a[96:111], v[60:63], v[40:43], a[96:111]
    v_mfma_f32_32x32x16_bf16 a[112:127], v[64:67], v[40:43], a[112:127]
    s_waitcnt lgkmcnt(0)
    s_waitcnt vmcnt(12)
    s_barrier
    s_mul_i32 s44, s40, 8192
    s_add_u32 m0, s44, 0
    s_add_u32 s43, s41, 1152
    buffer_load_dwordx4 v8, s[8:11], s43 offen lds
    s_mul_i32 s44, s40, 8192
    s_add_u32 m0, s44, 1024
    s_add_u32 s43, s41, 11392
    buffer_load_dwordx4 v9, s[8:11], s43 offen lds
    s_mul_i32 s44, s40, 8192
    s_add_u32 m0, s44, 2048
    s_add_u32 s43, s41, 21632
    buffer_load_dwordx4 v8, s[8:11], s43 offen lds
    s_mul_i32 s44, s40, 8192
    s_add_u32 m0, s44, 3072
    s_add_u32 s43, s41, 31872
    buffer_load_dwordx4 v9, s[8:11], s43 offen lds
    s_mul_i32 s44, s40, 8192
    s_add_u32 m0, s44, 4096
    s_add_u32 s43, s41, 42112
    buffer_load_dwordx4 v8, s[8:11], s43 offen lds
    s_mul_i32 s44, s40, 8192
    s_add_u32 m0, s44, 5120
    s_add_u32 s43, s41, 52352
    buffer_load_dwordx4 v9, s[8:11], s43 offen lds
    s_mul_i32 s44, s40, 8192
    s_add_u32 m0, s44, 6144
    s_add_u32 s43, s41, 62592
    buffer_load_dwordx4 v8, s[8:11], s43 offen lds
    s_mul_i32 s44, s40, 8192
    s_add_u32 m0, s44, 7168
    s_add_u32 s43, s41, 72832
    buffer_load_dwordx4 v9, s[8:11], s43 offen lds
    s_lshl_b32 s44, s40, 12
    s_add_u32 m0, s44, 32768
    s_mul_i32 s43, s26, 576
    s_add_u32 s43, s43, s42
    buffer_load_dwordx4 v10, s[12:15], s43 offen lds
    s_lshl_b32 s44, s40, 12
    s_add_u32 m0, s44, 33792
    s_mul_i32 s43, s26, 580
    s_add_u32 s43, s43, s42
    buffer_load_dwordx4 v10, s[12:15], s43 offen lds
    s_lshl_b32 s44, s40, 12
    s_add_u32 m0, s44, 34816
    s_mul_i32 s43, s26, 584
    s_add_u32 s43, s43, s42
    buffer_load_dwordx4 v10, s[12:15], s43 offen lds
    s_lshl_b32 s44, s40, 12
    s_add_u32 m0, s44, 35840
    s_mul_i32 s43, s26, 588
    s_add_u32 s43, s43, s42
    buffer_load_dwordx4 v10, s[12:15], s43 offen lds
    v_add_u32 v17, 49152, v11
    v_add_u32 v18, 49152, v12
    v_add_u32 v19, 49152, v13
    v_add_u32 v20, 49152, v14
    v_add_u32 v21, 49152, v15
    v_add_u32 v22, 49152, v16
    ds_read_b128 v[28:31], v17 offset:0
    ds_read_b128 v[32:35], v17 offset:4096
    ds_read_b128 v[36:39], v17 offset:8192
    ds_read_b128 v[40:43], v17 offset:12288
    ds_read_b64_tr_b16 v[60:61], v21 offset:0
    ds_read_b64_tr_b16 v[62:63], v21 offset:1024
    ds_read_b64_tr_b16 v[64:65], v22 offset:0
    ds_read_b64_tr_b16 v[66:67], v22 offset:1024
    v_mfma_f32_32x32x16_bf16 a[0:15], v[68:71], v[44:47], a[0:15]
    v_mfma_f32_32x32x16_bf16 a[16:31], v[72:75], v[44:47], a[16:31]
    v_mfma_f32_32x32x16_bf16 a[32:47], v[68:71], v[48:51], a[32:47]
    v_mfma_f32_32x32x16_bf16 a[48:63], v[72:75], v[48:51], a[48:63]
    v_mfma_f32_32x32x16_bf16 a[64:79], v[68:71], v[52:55], a[64:79]
    v_mfma_f32_32x32x16_bf16 a[80:95], v[72:75], v[52:55], a[80:95]
    v_mfma_f32_32x32x16_bf16 a[96:111], v[68:71], v[56:59], a[96:111]
    v_mfma_f32_32x32x16_bf16 a[112:127], v[72:75], v[56:59], a[112:127]
    ds_read_b128 v[44:47], v18 offset:0
    ds_read_b128 v[48:51], v18 offset:4096
    ds_read_b128 v[52:55], v18 offset:8192
    ds_read_b128 v[56:59], v18 offset:12288
    ds_read_b64_tr_b16 v[68:69], v21 offset:4096
    ds_read_b64_tr_b16 v[70:71], v21 offset:5120
    ds_read_b64_tr_b16 v[72:73], v22 offset:4096
    ds_read_b64_tr_b16 v[74:75], v22 offset:5120
    s_waitcnt lgkmcnt(8)
    v_mfma_f32_32x32x16_bf16 a[0:15], v[60:63], v[28:31], a[0:15]
    v_mfma_f32_32x32x16_bf16 a[16:31], v[64:67], v[28:31], a[16:31]
    v_mfma_f32_32x32x16_bf16 a[32:47], v[60:63], v[32:35], a[32:47]
    v_mfma_f32_32x32x16_bf16 a[48:63], v[64:67], v[32:35], a[48:63]
    v_mfma_f32_32x32x16_bf16 a[64:79], v[60:63], v[36:39], a[64:79]
    v_mfma_f32_32x32x16_bf16 a[80:95], v[64:67], v[36:39], a[80:95]
    v_mfma_f32_32x32x16_bf16 a[96:111], v[60:63], v[40:43], a[96:111]
    v_mfma_f32_32x32x16_bf16 a[112:127], v[64:67], v[40:43], a[112:127]
    ds_read_b128 v[28:31], v19 offset:0
    ds_read_b128 v[32:35], v19 offset:4096
    ds_read_b128 v[36:39], v19 offset:8192
    ds_read_b128 v[40:43], v19 offset:12288
    ds_read_b64_tr_b16 v[60:61], v21 offset:8192
    ds_read_b64_tr_b16 v[62:63], v21 offset:9216
    ds_read_b64_tr_b16 v[64:65], v22 offset:8192
    ds_read_b64_tr_b16 v[66:67], v22 offset:9216
    s_waitcnt lgkmcnt(8)
    v_mfma_f32_32x32x16_bf16 a[0:15], v[68:71], v[44:47], a[0:15]
    v_mfma_f32_32x32x16_bf16 a[16:31], v[72:75], v[44:47], a[16:31]
    v_mfma_f32_32x32x16_bf16 a[32:47], v[68:71], v[48:51], a[32:47]
    v_mfma_f32_32x32x16_bf16 a[48:63], v[72:75], v[48:51], a[48:63]
    v_mfma_f32_32x32x16_bf16 a[64:79], v[68:71], v[52:55], a[64:79]
    v_mfma_f32_32x32x16_bf16 a[80:95], v[72:75], v[52:55], a[80:95]
    v_mfma_f32_32x32x16_bf16 a[96:111], v[68:71], v[56:59], a[96:111]
    v_mfma_f32_32x32x16_bf16 a[112:127], v[72:75], v[56:59], a[112:127]
    ds_read_b128 v[44:47], v20 offset:0
    ds_read_b128 v[48:51], v20 offset:4096
    ds_read_b128 v[52:55], v20 offset:8192
    ds_read_b128 v[56:59], v20 offset:12288
    ds_read_b64_tr_b16 v[68:69], v21 offset:12288
    ds_read_b64_tr_b16 v[70:71], v21 offset:13312
    ds_read_b64_tr_b16 v[72:73], v22 offset:12288
    ds_read_b64_tr_b16 v[74:75], v22 offset:13312
    s_waitcnt lgkmcnt(8)
    v_mfma_f32_32x32x16_bf16 a[0:15], v[60:63], v[28:31], a[0:15]
    v_mfma_f32_32x32x16_bf16 a[16:31], v[64:67], v[28:31], a[16:31]
    v_mfma_f32_32x32x16_bf16 a[32:47], v[60:63], v[32:35], a[32:47]
    v_mfma_f32_32x32x16_bf16 a[48:63], v[64:67], v[32:35], a[48:63]
    v_mfma_f32_32x32x16_bf16 a[64:79], v[60:63], v[36:39], a[64:79]
    v_mfma_f32_32x32x16_bf16 a[80:95], v[64:67], v[36:39], a[80:95]
    v_mfma_f32_32x32x16_bf16 a[96:111], v[60:63], v[40:43], a[96:111]
    v_mfma_f32_32x32x16_bf16 a[112:127], v[64:67], v[40:43], a[112:127]
    s_waitcnt lgkmcnt(0)
    s_waitcnt vmcnt(12)
    s_barrier
    v_add_u32 v17, 98304, v11
    v_add_u32 v18, 98304, v12
    v_add_u32 v19, 98304, v13
    v_add_u32 v20, 98304, v14
    v_add_u32 v21, 98304, v15
    v_add_u32 v22, 98304, v16
    ds_read_b128 v[28:31], v17 offset:0
    ds_read_b128 v[32:35], v17 offset:4096
    ds_read_b128 v[36:39], v17 offset:8192
    ds_read_b128 v[40:43], v17 offset:12288
    ds_read_b64_tr_b16 v[60:61], v21 offset:0
    ds_read_b64_tr_b16 v[62:63], v21 offset:1024
    ds_read_b64_tr_b16 v[64:65], v22 offset:0
    ds_read_b64_tr_b16 v[66:67], v22 offset:1024
    v_mfma_f32_32x32x16_bf16 a[0:15], v[68:71], v[44:47], a[0:15]
    v_mfma_f32_32x32x16_bf16 a[16:31], v[72:75], v[44:47], a[16:31]
    v_mfma_f32_32x32x16_bf16 a[32:47], v[68:71], v[48:51], a[32:47]
    v_mfma_f32_32x32x16_bf16 a[48:63], v[72:75], v[48:51], a[48:63]
    v_mfma_f32_32x32x16_bf16 a[64:79], v[68:71], v[52:55], a[64:79]
    v_mfma_f32_32x32x16_bf16 a[80:95], v[72:75], v[52:55], a[80:95]
    v_mfma_f32_32x32x16_bf16 a[96:111], v[68:71], v[56:59], a[96:111]
    v_mfma_f32_32x32x16_bf16 a[112:127], v[72:75], v[56:59], a[112:127]
    ds_read_b128 v[44:47], v18 offset:0
    ds_read_b128 v[48:51], v18 offset:4096
    ds_read_b128 v[52:55], v18 offset:8192
    ds_read_b128 v[56:59], v18 offset:12288
    ds_read_b64_tr_b16 v[68:69], v21 offset:4096
    ds_read_b64_tr_b16 v[70:71], v21 offset:5120
    ds_read_b64_tr_b16 v[72:73], v22 offset:4096
    ds_read_b64_tr_b16 v[74:75], v22 offset:5120
    s_waitcnt lgkmcnt(8)
    v_mfma_f32_32x32x16_bf16 a[0:15], v[60:63], v[28:31], a[0:15]
    v_mfma_f32_32x32x16_bf16 a[16:31], v[64:67], v[28:31], a[16:31]
    v_mfma_f32_32x32x16_bf16 a[32:47], v[60:63], v[32:35], a[32:47]
    v_mfma_f32_32x32x16_bf16 a[48:63], v[64:67], v[32:35], a[48:63]
    v_mfma_f32_32x32x16_bf16 a[64:79], v[60:63], v[36:39], a[64:79]
    v_mfma_f32_32x32x16_bf16 a[80:95], v[64:67], v[36:39], a[80:95]
    v_mfma_f32_32x32x16_bf16 a[96:111], v[60:63], v[40:43], a[96:111]
    v_mfma_f32_32x32x16_bf16 a[112:127], v[64:67], v[40:43], a[112:127]
    ds_read_b128 v[28:31], v19 offset:0
    ds_read_b128 v[32:35], v19 offset:4096
    ds_read_b128 v[36:39], v19 offset:8192
    ds_read_b128 v[40:43], v19 offset:12288
    ds_read_b64_tr_b16 v[60:61], v21 offset:8192
    ds_read_b64_tr_b16 v[62:63], v21 offset:9216
    ds_read_b64_tr_b16 v[64:65], v22 offset:8192
    ds_read_b64_tr_b16 v[66:67], v22 offset:9216
    s_waitcnt lgkmcnt(8)
    v_mfma_f32_32x32x16_bf16 a[0:15], v[68:71], v[44:47], a[0:15]
    v_mfma_f32_32x32x16_bf16 a[16:31], v[72:75], v[44:47], a[16:31]
    v_mfma_f32_32x32x16_bf16 a[32:47], v[68:71], v[48:51], a[32:47]
    v_mfma_f32_32x32x16_bf16 a[48:63], v[72:75], v[48:51], a[48:63]
    v_mfma_f32_32x32x16_bf16 a[64:79], v[68:71], v[52:55], a[64:79]
    v_mfma_f32_32x32x16_bf16 a[80:95], v[72:75], v[52:55], a[80:95]
    v_mfma_f32_32x32x16_bf16 a[96:111], v[68:71], v[56:59], a[96:111]
    v_mfma_f32_32x32x16_bf16 a[112:127], v[72:75], v[56:59], a[112:127]
    ds_read_b128 v[44:47], v20 offset:0
    ds_read_b128 v[48:51], v20 offset:4096
    ds_read_b128 v[52:55], v20 offset:8192
    ds_read_b128 v[56:59], v20 offset:12288
    ds_read_b64_tr_b16 v[68:69], v21 offset:12288
    ds_read_b64_tr_b16 v[70:71], v21 offset:13312
    ds_read_b64_tr_b16 v[72:73], v22 offset:12288
    ds_read_b64_tr_b16 v[74:75], v22 offset:13312
    s_waitcnt lgkmcnt(8)
    v_mfma_f32_32x32x16_bf16 a[0:15], v[60:63], v[28:31], a[0:15]
    v_mfma_f32_32x32x16_bf16 a[16:31], v[64:67], v[28:31], a[16:31]
    v_mfma_f32_32x32x16_bf16 a[32:47], v[60:63], v[32:35], a[32:47]
    v_mfma_f32_32x32x16_bf16 a[48:63], v[64:67], v[32:35], a[48:63]
    v_mfma_f32_32x32x16_bf16 a[64:79], v[60:63], v[36:39], a[64:79]
    v_mfma_f32_32x32x16_bf16 a[80:95], v[64:67], v[36:39], a[80:95]
    v_mfma_f32_32x32x16_bf16 a[96:111], v[60:63], v[40:43], a[96:111]
    v_mfma_f32_32x32x16_bf16 a[112:127], v[64:67], v[40:43], a[112:127]
    s_waitcnt lgkmcnt(0)
    s_waitcnt vmcnt(0)
    s_barrier
    v_add_u32 v17, 0, v11
    v_add_u32 v18, 0, v12
    v_add_u32 v19, 0, v13
    v_add_u32 v20, 0, v14
    v_add_u32 v21, 0, v15
    v_add_u32 v22, 0, v16
    ds_read_b128 v[28:31], v17 offset:0
    ds_read_b128 v[32:35], v17 offset:4096
    ds_read_b128 v[36:39], v17 offset:8192
    ds_read_b128 v[40:43], v17 offset:12288
    ds_read_b64_tr_b16 v[60:61], v21 offset:0
    ds_read_b64_tr_b16 v[62:63], v21 offset:1024
    ds_read_b64_tr_b16 v[64:65], v22 offset:0
    ds_read_b64_tr_b16 v[66:67], v22 offset:1024
    v_mfma_f32_32x32x16_bf16 a[0:15], v[68:71], v[44:47], a[0:15]
    v_mfma_f32_32x32x16_bf16 a[16:31], v[72:75], v[44:47], a[16:31]
    v_mfma_f32_32x32x16_bf16 a[32:47], v[68:71], v[48:51], a[32:47]
    v_mfma_f32_32x32x16_bf16 a[48:63], v[72:75], v[48:51], a[48:63]
    v_mfma_f32_32x32x16_bf16 a[64:79], v[68:71], v[52:55], a[64:79]
    v_mfma_f32_32x32x16_bf16 a[80:95], v[72:75], v[52:55], a[80:95]
    v_mfma_f32_32x32x16_bf16 a[96:111], v[68:71], v[56:59], a[96:111]
    v_mfma_f32_32x32x16_bf16 a[112:127], v[72:75], v[56:59], a[112:127]
    ds_read_b128 v[44:47], v18 offset:0
    ds_read_b128 v[48:51], v18 offset:4096
    ds_read_b128 v[52:55], v18 offset:8192
    ds_read_b128 v[56:59], v18 offset:12288
    ds_read_b64_tr_b16 v[68:69], v21 offset:4096
    ds_read_b64_tr_b16 v[70:71], v21 offset:5120
    ds_read_b64_tr_b16 v[72:73], v22 offset:4096
    ds_read_b64_tr_b16 v[74:75], v22 offset:5120
    s_waitcnt lgkmcnt(8)
    v_mfma_f32_32x32x16_bf16 a[0:15], v[60:63], v[28:31], a[0:15]
    v_mfma_f32_32x32x16_bf16 a[16:31], v[64:67], v[28:31], a[16:31]
    v_mfma_f32_32x32x16_bf16 a[32:47], v[60:63], v[32:35], a[32:47]
    v_mfma_f32_32x32x16_bf16 a[48:63], v[64:67], v[32:35], a[48:63]
    v_mfma_f32_32x32x16_bf16 a[64:79], v[60:63], v[36:39], a[64:79]
    v_mfma_f32_32x32x16_bf16 a[80:95], v[64:67], v[36:39], a[80:95]
    v_mfma_f32_32x32x16_bf16 a[96:111], v[60:63], v[40:43], a[96:111]
    v_mfma_f32_32x32x16_bf16 a[112:127], v[64:67], v[40:43], a[112:127]
    ds_read_b128 v[28:31], v19 offset:0
    ds_read_b128 v[32:35], v19 offset:4096
    ds_read_b128 v[36:39], v19 offset:8192
    ds_read_b128 v[40:43], v19 offset:12288
    ds_read_b64_tr_b16 v[60:61], v21 offset:8192
    ds_read_b64_tr_b16 v[62:63], v21 offset:9216
    ds_read_b64_tr_b16 v[64:65], v22 offset:8192
    ds_read_b64_tr_b16 v[66:67], v22 offset:9216
    s_waitcnt lgkmcnt(8)
    v_mfma_f32_32x32x16_bf16 a[0:15], v[68:71], v[44:47], a[0:15]
    v_mfma_f32_32x32x16_bf16 a[16:31], v[72:75], v[44:47], a[16:31]
    v_mfma_f32_32x32x16_bf16 a[32:47], v[68:71], v[48:51], a[32:47]
    v_mfma_f32_32x32x16_bf16 a[48:63], v[72:75], v[48:51], a[48:63]
    v_mfma_f32_32x32x16_bf16 a[64:79], v[68:71], v[52:55], a[64:79]
    v_mfma_f32_32x32x16_bf16 a[80:95], v[72:75], v[52:55], a[80:95]
    v_mfma_f32_32x32x16_bf16 a[96:111], v[68:71], v[56:59], a[96:111]
    v_mfma_f32_32x32x16_bf16 a[112:127], v[72:75], v[56:59], a[112:127]
    ds_read_b128 v[44:47], v20 offset:0
    ds_read_b128 v[48:51], v20 offset:4096
    ds_read_b128 v[52:55], v20 offset:8192
    ds_read_b128 v[56:59], v20 offset:12288
    ds_read_b64_tr_b16 v[68:69], v21 offset:12288
    ds_read_b64_tr_b16 v[70:71], v21 offset:13312
    ds_read_b64_tr_b16 v[72:73], v22 offset:12288
    ds_read_b64_tr_b16 v[74:75], v22 offset:13312
    s_waitcnt lgkmcnt(8)
    v_mfma_f32_32x32x16_bf16 a[0:15], v[60:63], v[28:31], a[0:15]
    v_mfma_f32_32x32x16_bf16 a[16:31], v[64:67], v[28:31], a[16:31]
    v_mfma_f32_32x32x16_bf16 a[32:47], v[60:63], v[32:35], a[32:47]
    v_mfma_f32_32x32x16_bf16 a[48:63], v[64:67], v[32:35], a[48:63]
    v_mfma_f32_32x32x16_bf16 a[64:79], v[60:63], v[36:39], a[64:79]
    v_mfma_f32_32x32x16_bf16 a[80:95], v[64:67], v[36:39], a[80:95]
    v_mfma_f32_32x32x16_bf16 a[96:111], v[60:63], v[40:43], a[96:111]
    v_mfma_f32_32x32x16_bf16 a[112:127], v[64:67], v[40:43], a[112:127]
    s_waitcnt lgkmcnt(0)
    v_mfma_f32_32x32x16_bf16 a[0:15], v[68:71], v[44:47], a[0:15]
    v_mfma_f32_32x32x16_bf16 a[16:31], v[72:75], v[44:47], a[16:31]
    v_mfma_f32_32x32x16_bf16 a[32:47], v[68:71], v[48:51], a[32:47]
    v_mfma_f32_32x32x16_bf16 a[48:63], v[72:75], v[48:51], a[48:63]
    v_mfma_f32_32x32x16_bf16 a[64:79], v[68:71], v[52:55], a[64:79]
    v_mfma_f32_32x32x16_bf16 a[80:95], v[72:75], v[52:55], a[80:95]
    v_mfma_f32_32x32x16_bf16 a[96:111], v[68:71], v[56:59], a[96:111]
    v_mfma_f32_32x32x16_bf16 a[112:127], v[72:75], v[56:59], a[112:127]
    s_nop 15
    s_waitcnt lgkmcnt(0)
    s_barrier
    v_and_b32 v3, 63, v0
    v_and_b32 v4, 31, v3
    s_lshr_b32 s30, s40, 1
    s_mul_i32 s30, s30, 128
    v_add_u32 v4, s30, v4
    v_mul_u32_u24 v1, 272, v4
    v_lshrrev_b32 v4, 5, v3
    v_mul_u32_u24 v4, 8, v4
    v_add_u32 v1, v4, v1
    s_and_b32 s30, s40, 1
    s_mul_i32 s30, s30, 128
    v_add_u32 v1, s30, v1
    v_accvgpr_read_b32 v76, a0
    v_accvgpr_read_b32 v77, a1
    v_accvgpr_read_b32 v78, a2
    v_accvgpr_read_b32 v79, a3
    v_max_f32 v76, s29, v76
    v_max_f32 v77, s29, v77
    v_max_f32 v78, s29, v78
    v_max_f32 v79, s29, v79
    v_cvt_pk_bf16_f32 v80, v76, v77
    v_cvt_pk_bf16_f32 v81, v78, v79
    ds_write_b64 v1, v[80:81] offset:0
    v_accvgpr_read_b32 v76, a4
    v_accvgpr_read_b32 v77, a5
    v_accvgpr_read_b32 v78, a6
    v_accvgpr_read_b32 v79, a7
    v_max_f32 v76, s29, v76
    v_max_f32 v77, s29, v77
    v_max_f32 v78, s29, v78
    v_max_f32 v79, s29, v79
    v_cvt_pk_bf16_f32 v80, v76, v77
    v_cvt_pk_bf16_f32 v81, v78, v79
    ds_write_b64 v1, v[80:81] offset:16
    v_accvgpr_read_b32 v76, a8
    v_accvgpr_read_b32 v77, a9
    v_accvgpr_read_b32 v78, a10
    v_accvgpr_read_b32 v79, a11
    v_max_f32 v76, s29, v76
    v_max_f32 v77, s29, v77
    v_max_f32 v78, s29, v78
    v_max_f32 v79, s29, v79
    v_cvt_pk_bf16_f32 v80, v76, v77
    v_cvt_pk_bf16_f32 v81, v78, v79
    ds_write_b64 v1, v[80:81] offset:32
    v_accvgpr_read_b32 v76, a12
    v_accvgpr_read_b32 v77, a13
    v_accvgpr_read_b32 v78, a14
    v_accvgpr_read_b32 v79, a15
    v_max_f32 v76, s29, v76
    v_max_f32 v77, s29, v77
    v_max_f32 v78, s29, v78
    v_max_f32 v79, s29, v79
    v_cvt_pk_bf16_f32 v80, v76, v77
    v_cvt_pk_bf16_f32 v81, v78, v79
    ds_write_b64 v1, v[80:81] offset:48
    v_accvgpr_read_b32 v76, a16
    v_accvgpr_read_b32 v77, a17
    v_accvgpr_read_b32 v78, a18
    v_accvgpr_read_b32 v79, a19
    v_max_f32 v76, s29, v76
    v_max_f32 v77, s29, v77
    v_max_f32 v78, s29, v78
    v_max_f32 v79, s29, v79
    v_cvt_pk_bf16_f32 v80, v76, v77
    v_cvt_pk_bf16_f32 v81, v78, v79
    ds_write_b64 v1, v[80:81] offset:64
    v_accvgpr_read_b32 v76, a20
    v_accvgpr_read_b32 v77, a21
    v_accvgpr_read_b32 v78, a22
    v_accvgpr_read_b32 v79, a23
    v_max_f32 v76, s29, v76
    v_max_f32 v77, s29, v77
    v_max_f32 v78, s29, v78
    v_max_f32 v79, s29, v79
    v_cvt_pk_bf16_f32 v80, v76, v77
    v_cvt_pk_bf16_f32 v81, v78, v79
    ds_write_b64 v1, v[80:81] offset:80
    v_accvgpr_read_b32 v76, a24
    v_accvgpr_read_b32 v77, a25
    v_accvgpr_read_b32 v78, a26
    v_accvgpr_read_b32 v79, a27
    v_max_f32 v76, s29, v76
    v_max_f32 v77, s29, v77
    v_max_f32 v78, s29, v78
    v_max_f32 v79, s29, v79
    v_cvt_pk_bf16_f32 v80, v76, v77
    v_cvt_pk_bf16_f32 v81, v78, v79
    ds_write_b64 v1, v[80:81] offset:96
    v_accvgpr_read_b32 v76, a28
    v_accvgpr_read_b32 v77, a29
    v_accvgpr_read_b32 v78, a30
    v_accvgpr_read_b32 v79, a31
    v_max_f32 v76, s29, v76
    v_max_f32 v77, s29, v77
    v_max_f32 v78, s29, v78
    v_max_f32 v79, s29, v79
    v_cvt_pk_bf16_f32 v80, v76, v77
    v_cvt_pk_bf16_f32 v81, v78, v79
    ds_write_b64 v1, v[80:81] offset:112
    v_accvgpr_read_b32 v76, a32
    v_accvgpr_read_b32 v77, a33
    v_accvgpr_read_b32 v78, a34
    v_accvgpr_read_b32 v79, a35
    v_max_f32 v76, s29, v76
    v_max_f32 v77, s29, v77
    v_max_f32 v78, s29, v78
    v_max_f32 v79, s29, v79
    v_cvt_pk_bf16_f32 v80, v76, v77
    v_cvt_pk_bf16_f32 v81, v78, v79
    ds_write_b64 v1, v[80:81] offset:8704
    v_accvgpr_read_b32 v76, a36
    v_accvgpr_read_b32 v77, a37
    v_accvgpr_read_b32 v78, a38
    v_accvgpr_read_b32 v79, a39
    v_max_f32 v76, s29, v76
    v_max_f32 v77, s29, v77
    v_max_f32 v78, s29, v78
    v_max_f32 v79, s29, v79
    v_cvt_pk_bf16_f32 v80, v76, v77
    v_cvt_pk_bf16_f32 v81, v78, v79
    ds_write_b64 v1, v[80:81] offset:8720
    v_accvgpr_read_b32 v76, a40
    v_accvgpr_read_b32 v77, a41
    v_accvgpr_read_b32 v78, a42
    v_accvgpr_read_b32 v79, a43
    v_max_f32 v76, s29, v76
    v_max_f32 v77, s29, v77
    v_max_f32 v78, s29, v78
    v_max_f32 v79, s29, v79
    v_cvt_pk_bf16_f32 v80, v76, v77
    v_cvt_pk_bf16_f32 v81, v78, v79
    ds_write_b64 v1, v[80:81] offset:8736
    v_accvgpr_read_b32 v76, a44
    v_accvgpr_read_b32 v77, a45
    v_accvgpr_read_b32 v78, a46
    v_accvgpr_read_b32 v79, a47
    v_max_f32 v76, s29, v76
    v_max_f32 v77, s29, v77
    v_max_f32 v78, s29, v78
    v_max_f32 v79, s29, v79
    v_cvt_pk_bf16_f32 v80, v76, v77
    v_cvt_pk_bf16_f32 v81, v78, v79
    ds_write_b64 v1, v[80:81] offset:8752
    v_accvgpr_read_b32 v76, a48
    v_accvgpr_read_b32 v77, a49
    v_accvgpr_read_b32 v78, a50
    v_accvgpr_read_b32 v79, a51
    v_max_f32 v76, s29, v76
    v_max_f32 v77, s29, v77
    v_max_f32 v78, s29, v78
    v_max_f32 v79, s29, v79
    v_cvt_pk_bf16_f32 v80, v76, v77
    v_cvt_pk_bf16_f32 v81, v78, v79
    ds_write_b64 v1, v[80:81] offset:8768
    v_accvgpr_read_b32 v76, a52
    v_accvgpr_read_b32 v77, a53
    v_accvgpr_read_b32 v78, a54
    v_accvgpr_read_b32 v79, a55
    v_max_f32 v76, s29, v76
    v_max_f32 v77, s29, v77
    v_max_f32 v78, s29, v78
    v_max_f32 v79, s29, v79
    v_cvt_pk_bf16_f32 v80, v76, v77
    v_cvt_pk_bf16_f32 v81, v78, v79
    ds_write_b64 v1, v[80:81] offset:8784
    v_accvgpr_read_b32 v76, a56
    v_accvgpr_read_b32 v77, a57
    v_accvgpr_read_b32 v78, a58
    v_accvgpr_read_b32 v79, a59
    v_max_f32 v76, s29, v76
    v_max_f32 v77, s29, v77
    v_max_f32 v78, s29, v78
    v_max_f32 v79, s29, v79
    v_cvt_pk_bf16_f32 v80, v76, v77
    v_cvt_pk_bf16_f32 v81, v78, v79
    ds_write_b64 v1, v[80:81] offset:8800
    v_accvgpr_read_b32 v76, a60
    v_accvgpr_read_b32 v77, a61
    v_accvgpr_read_b32 v78, a62
    v_accvgpr_read_b32 v79, a63
    v_max_f32 v76, s29, v76
    v_max_f32 v77, s29, v77
    v_max_f32 v78, s29, v78
    v_max_f32 v79, s29, v79
    v_cvt_pk_bf16_f32 v80, v76, v77
    v_cvt_pk_bf16_f32 v81, v78, v79
    ds_write_b64 v1, v[80:81] offset:8816
    v_accvgpr_read_b32 v76, a64
    v_accvgpr_read_b32 v77, a65
    v_accvgpr_read_b32 v78, a66
    v_accvgpr_read_b32 v79, a67
    v_max_f32 v76, s29, v76
    v_max_f32 v77, s29, v77
    v_max_f32 v78, s29, v78
    v_max_f32 v79, s29, v79
    v_cvt_pk_bf16_f32 v80, v76, v77
    v_cvt_pk_bf16_f32 v81, v78, v79
    ds_write_b64 v1, v[80:81] offset:17408
    v_accvgpr_read_b32 v76, a68
    v_accvgpr_read_b32 v77, a69
    v_accvgpr_read_b32 v78, a70
    v_accvgpr_read_b32 v79, a71
    v_max_f32 v76, s29, v76
    v_max_f32 v77, s29, v77
    v_max_f32 v78, s29, v78
    v_max_f32 v79, s29, v79
    v_cvt_pk_bf16_f32 v80, v76, v77
    v_cvt_pk_bf16_f32 v81, v78, v79
    ds_write_b64 v1, v[80:81] offset:17424
    v_accvgpr_read_b32 v76, a72
    v_accvgpr_read_b32 v77, a73
    v_accvgpr_read_b32 v78, a74
    v_accvgpr_read_b32 v79, a75
    v_max_f32 v76, s29, v76
    v_max_f32 v77, s29, v77
    v_max_f32 v78, s29, v78
    v_max_f32 v79, s29, v79
    v_cvt_pk_bf16_f32 v80, v76, v77
    v_cvt_pk_bf16_f32 v81, v78, v79
    ds_write_b64 v1, v[80:81] offset:17440
    v_accvgpr_read_b32 v76, a76
    v_accvgpr_read_b32 v77, a77
    v_accvgpr_read_b32 v78, a78
    v_accvgpr_read_b32 v79, a79
    v_max_f32 v76, s29, v76
    v_max_f32 v77, s29, v77
    v_max_f32 v78, s29, v78
    v_max_f32 v79, s29, v79
    v_cvt_pk_bf16_f32 v80, v76, v77
    v_cvt_pk_bf16_f32 v81, v78, v79
    ds_write_b64 v1, v[80:81] offset:17456
    v_accvgpr_read_b32 v76, a80
    v_accvgpr_read_b32 v77, a81
    v_accvgpr_read_b32 v78, a82
    v_accvgpr_read_b32 v79, a83
    v_max_f32 v76, s29, v76
    v_max_f32 v77, s29, v77
    v_max_f32 v78, s29, v78
    v_max_f32 v79, s29, v79
    v_cvt_pk_bf16_f32 v80, v76, v77
    v_cvt_pk_bf16_f32 v81, v78, v79
    ds_write_b64 v1, v[80:81] offset:17472
    v_accvgpr_read_b32 v76, a84
    v_accvgpr_read_b32 v77, a85
    v_accvgpr_read_b32 v78, a86
    v_accvgpr_read_b32 v79, a87
    v_max_f32 v76, s29, v76
    v_max_f32 v77, s29, v77
    v_max_f32 v78, s29, v78
    v_max_f32 v79, s29, v79
    v_cvt_pk_bf16_f32 v80, v76, v77
    v_cvt_pk_bf16_f32 v81, v78, v79
    ds_write_b64 v1, v[80:81] offset:17488
    v_accvgpr_read_b32 v76, a88
    v_accvgpr_read_b32 v77, a89
    v_accvgpr_read_b32 v78, a90
    v_accvgpr_read_b32 v79, a91
    v_max_f32 v76, s29, v76
    v_max_f32 v77, s29, v77
    v_max_f32 v78, s29, v78
    v_max_f32 v79, s29, v79
    v_cvt_pk_bf16_f32 v80, v76, v77
    v_cvt_pk_bf16_f32 v81, v78, v79
    ds_write_b64 v1, v[80:81] offset:17504
    v_accvgpr_read_b32 v76, a92
    v_accvgpr_read_b32 v77, a93
    v_accvgpr_read_b32 v78, a94
    v_accvgpr_read_b32 v79, a95
    v_max_f32 v76, s29, v76
    v_max_f32 v77, s29, v77
    v_max_f32 v78, s29, v78
    v_max_f32 v79, s29, v79
    v_cvt_pk_bf16_f32 v80, v76, v77
    v_cvt_pk_bf16_f32 v81, v78, v79
    ds_write_b64 v1, v[80:81] offset:17520
    v_accvgpr_read_b32 v76, a96
    v_accvgpr_read_b32 v77, a97
    v_accvgpr_read_b32 v78, a98
    v_accvgpr_read_b32 v79, a99
    v_max_f32 v76, s29, v76
    v_max_f32 v77, s29, v77
    v_max_f32 v78, s29, v78
    v_max_f32 v79, s29, v79
    v_cvt_pk_bf16_f32 v80, v76, v77
    v_cvt_pk_bf16_f32 v81, v78, v79
    ds_write_b64 v1, v[80:81] offset:26112
    v_accvgpr_read_b32 v76, a100
    v_accvgpr_read_b32 v77, a101
    v_accvgpr_read_b32 v78, a102
    v_accvgpr_read_b32 v79, a103
    v_max_f32 v76, s29, v76
    v_max_f32 v77, s29, v77
    v_max_f32 v78, s29, v78
    v_max_f32 v79, s29, v79
    v_cvt_pk_bf16_f32 v80, v76, v77
    v_cvt_pk_bf16_f32 v81, v78, v79
    ds_write_b64 v1, v[80:81] offset:26128
    v_accvgpr_read_b32 v76, a104
    v_accvgpr_read_b32 v77, a105
    v_accvgpr_read_b32 v78, a106
    v_accvgpr_read_b32 v79, a107
    v_max_f32 v76, s29, v76
    v_max_f32 v77, s29, v77
    v_max_f32 v78, s29, v78
    v_max_f32 v79, s29, v79
    v_cvt_pk_bf16_f32 v80, v76, v77
    v_cvt_pk_bf16_f32 v81, v78, v79
    ds_write_b64 v1, v[80:81] offset:26144
    v_accvgpr_read_b32 v76, a108
    v_accvgpr_read_b32 v77, a109
    v_accvgpr_read_b32 v78, a110
    v_accvgpr_read_b32 v79, a111
    v_max_f32 v76, s29, v76
    v_max_f32 v77, s29, v77
    v_max_f32 v78, s29, v78
    v_max_f32 v79, s29, v79
    v_cvt_pk_bf16_f32 v80, v76, v77
    v_cvt_pk_bf16_f32 v81, v78, v79
    ds_write_b64 v1, v[80:81] offset:26160
    v_accvgpr_read_b32 v76, a112
    v_accvgpr_read_b32 v77, a113
    v_accvgpr_read_b32 v78, a114
    v_accvgpr_read_b32 v79, a115
    v_max_f32 v76, s29, v76
    v_max_f32 v77, s29, v77
    v_max_f32 v78, s29, v78
    v_max_f32 v79, s29, v79
    v_cvt_pk_bf16_f32 v80, v76, v77
    v_cvt_pk_bf16_f32 v81, v78, v79
    ds_write_b64 v1, v[80:81] offset:26176
    v_accvgpr_read_b32 v76, a116
    v_accvgpr_read_b32 v77, a117
    v_accvgpr_read_b32 v78, a118
    v_accvgpr_read_b32 v79, a119
    v_max_f32 v76, s29, v76
    v_max_f32 v77, s29, v77
    v_max_f32 v78, s29, v78
    v_max_f32 v79, s29, v79
    v_cvt_pk_bf16_f32 v80, v76, v77
    v_cvt_pk_bf16_f32 v81, v78, v79
    ds_write_b64 v1, v[80:81] offset:26192
    v_accvgpr_read_b32 v76, a120
    v_accvgpr_read_b32 v77, a121
    v_accvgpr_read_b32 v78, a122
    v_accvgpr_read_b32 v79, a123
    v_max_f32 v76, s29, v76
    v_max_f32 v77, s29, v77
    v_max_f32 v78, s29, v78
    v_max_f32 v79, s29, v79
    v_cvt_pk_bf16_f32 v80, v76, v77
    v_cvt_pk_bf16_f32 v81, v78, v79
    ds_write_b64 v1, v[80:81] offset:26208
    v_accvgpr_read_b32 v76, a124
    v_accvgpr_read_b32 v77, a125
    v_accvgpr_read_b32 v78, a126
    v_accvgpr_read_b32 v79, a127
    v_max_f32 v76, s29, v76
    v_max_f32 v77, s29, v77
    v_max_f32 v78, s29, v78
    v_max_f32 v79, s29, v79
    v_cvt_pk_bf16_f32 v80, v76, v77
    v_cvt_pk_bf16_f32 v81, v78, v79
    ds_write_b64 v1, v[80:81] offset:26224
    s_waitcnt lgkmcnt(0)
    s_barrier
    v_lshrrev_b32 v2, 4, v0
    v_and_b32 v3, 15, v0
    v_mul_u32_u24 v1, 272, v2
    v_lshl_add_u32 v1, v3, 4, v1
    s_mul_i32 s30, s21, 256
    v_add_u32 v2, s30, v2
    v_mul_u32_u24 v2, 6912, v2
    v_lshl_add_u32 v2, v3, 4, v2
    s_lshl_b32 s31, s20, 8
    v_add_u32 v2, s31, v2
    ds_read_b128 v[76:79], v1 offset:0
    s_waitcnt lgkmcnt(0)
    s_mov_b32 s31, 0
    buffer_store_dwordx4 v[76:79], v2, s[16:19], s31 offen
    ds_read_b128 v[80:83], v1 offset:4352
    s_waitcnt lgkmcnt(0)
    s_mov_b32 s31, 110592
    buffer_store_dwordx4 v[80:83], v2, s[16:19], s31 offen
    ds_read_b128 v[84:87], v1 offset:8704
    s_waitcnt lgkmcnt(0)
    s_mov_b32 s31, 221184
    buffer_store_dwordx4 v[84:87], v2, s[16:19], s31 offen
    ds_read_b128 v[88:91], v1 offset:13056
    s_waitcnt lgkmcnt(0)
    s_mov_b32 s31, 331776
    buffer_store_dwordx4 v[88:91], v2, s[16:19], s31 offen
    ds_read_b128 v[76:79], v1 offset:17408
    s_waitcnt lgkmcnt(0)
    s_mov_b32 s31, 442368
    buffer_store_dwordx4 v[76:79], v2, s[16:19], s31 offen
    ds_read_b128 v[80:83], v1 offset:21760
    s_waitcnt lgkmcnt(0)
    s_mov_b32 s31, 552960
    buffer_store_dwordx4 v[80:83], v2, s[16:19], s31 offen
    ds_read_b128 v[84:87], v1 offset:26112
    s_waitcnt lgkmcnt(0)
    s_mov_b32 s31, 663552
    buffer_store_dwordx4 v[84:87], v2, s[16:19], s31 offen
    ds_read_b128 v[88:91], v1 offset:30464
    s_waitcnt lgkmcnt(0)
    s_mov_b32 s31, 774144
    buffer_store_dwordx4 v[88:91], v2, s[16:19], s31 offen
    ds_read_b128 v[76:79], v1 offset:34816
    s_waitcnt lgkmcnt(0)
    s_mov_b32 s31, 884736
    buffer_store_dwordx4 v[76:79], v2, s[16:19], s31 offen
    ds_read_b128 v[80:83], v1 offset:39168
    s_waitcnt lgkmcnt(0)
    s_mov_b32 s31, 995328
    buffer_store_dwordx4 v[80:83], v2, s[16:19], s31 offen
    ds_read_b128 v[84:87], v1 offset:43520
    s_waitcnt lgkmcnt(0)
    s_mov_b32 s31, 1105920
    buffer_store_dwordx4 v[84:87], v2, s[16:19], s31 offen
    ds_read_b128 v[88:91], v1 offset:47872
    s_waitcnt lgkmcnt(0)
    s_mov_b32 s31, 1216512
    buffer_store_dwordx4 v[88:91], v2, s[16:19], s31 offen
    ds_read_b128 v[76:79], v1 offset:52224
    s_waitcnt lgkmcnt(0)
    s_mov_b32 s31, 1327104
    buffer_store_dwordx4 v[76:79], v2, s[16:19], s31 offen
    ds_read_b128 v[80:83], v1 offset:56576
    s_waitcnt lgkmcnt(0)
    s_mov_b32 s31, 1437696
    buffer_store_dwordx4 v[80:83], v2, s[16:19], s31 offen
    ds_read_b128 v[84:87], v1 offset:60928
    s_waitcnt lgkmcnt(0)
    s_mov_b32 s31, 1548288
    buffer_store_dwordx4 v[84:87], v2, s[16:19], s31 offen
    ds_read_b128 v[88:91], v1 offset:65280
    s_waitcnt lgkmcnt(0)
    s_mov_b32 s31, 1658880
    buffer_store_dwordx4 v[88:91], v2, s[16:19], s31 offen
gemm1_kernel_done1:
    s_endpgm
.globl mid_kernel
.p2align 8
.type mid_kernel,@function
mid_kernel:
    s_cmp_ge_u32 s2, 672
    s_cbranch_scc1 mid_kernel_done1
    s_load_dwordx2 s[4:5], s[0:1], 40
    s_load_dwordx2 s[24:25], s[0:1], 64
    s_mov_b32 s26, 6912
    s_sub_u32 s36, s2, 160
    s_waitcnt lgkmcnt(0)
    s_cmp_ge_u32 s2, 160
    s_cbranch_scc1 mid_kernel_att2
    s_mul_hi_u32 s21, s2, 0x33333334
    s_mul_i32 s20, s21, 5
    s_sub_u32 s20, s2, s20
    s_lshr_b32 s37, s21, 4
    s_and_b32 s21, s21, 15
    s_add_u32 s8, s24, 2621440
    s_addc_u32 s9, s25, 0
    s_and_b32 s9, s9, 0xffff
    s_mov_b32 s10, 14155776
    s_mov_b32 s11, 0x00020000
    s_add_u32 s16, s24, 20971520
    s_addc_u32 s17, s25, 0
    s_and_b32 s17, s17, 0xffff
    s_mov_b32 s18, 10485760
    s_mov_b32 s19, 0x00020000
    s_mov_b32 s12, s4
    s_and_b32 s13, s5, 0xffff
    s_mov_b32 s14, 1966080
    s_mov_b32 s15, 0x00020000
    s_mov_b32 s26, 1280
    s_mul_i32 s28, s21, 884736
    s_mul_i32 s29, s37, 1536
    s_add_u32 s28, s28, s29
    s_add_u32 s28, s28, 3840
    s_mul_i32 s27, s37, 983040
    s_lshl_b32 s29, s20, 8
    s_add_u32 s27, s27, s29
    v_lshrrev_b32 v23, 6, v0
    s_nop 0
    v_readfirstlane_b32 s40, v23
    v_and_b32 v24, 63, v0
    v_lshrrev_b32 v25, 3, v24
    v_mul_u32_u24 v8, 6912, v25
    v_lshrrev_b32 v25, 4, v24
    v_and_b32 v9, 7, v24
    v_xor_b32 v25, v25, v9
    v_xor_b32 v9, 4, v25
    v_lshl_add_u32 v9, v9, 4, v8
    v_lshl_add_u32 v8, v25, 4, v8
    v_lshrrev_b32 v25, 4, v24
    v_mul_lo_u32 v10, v25, s26
    v_lshlrev_b32 v25, 2, v25
    v_and_b32 v11, 15, v24
    v_xor_b32 v25, v25, v11
    v_lshl_add_u32 v10, v25, 4, v10
    s_mul_i32 s41, s40, 221184
    s_add_u32 s41, s41, s28
    s_lshl_b32 s43, s40, 4
    s_mul_i32 s42, s43, s26
    s_add_u32 s42, s42, s27
    s_lshr_b32 s43, s40, 1
    s_mul_i32 s43, s43, 8192
    v_and_b32 v25, 31, v24
    v_lshl_add_u32 v23, v25, 7, s43
    v_bfe_u32 v25, v24, 1, 3
    v_lshrrev_b32 v17, 5, v24
    v_add_u32 v18, 0, v17
    v_xor_b32 v18, v18, v25
    v_lshl_add_u32 v11, v18, 4, v23
    v_add_u32 v18, 2, v17
    v_xor_b32 v18, v18, v25
    v_lshl_add_u32 v12, v18, 4, v23
    v_add_u32 v18, 4, v17
    v_xor_b32 v18, v18, v25
    v_lshl_add_u32 v13, v18, 4, v23
    v_add_u32 v18, 6, v17
    v_xor_b32 v18, v18, v25
    v_lshl_add_u32 v14, v18, 4, v23
    v_lshrrev_b32 v23, 5, v24
    v_lshlrev_b32 v23, 3, v23
    v_bfe_u32 v25, v24, 2, 2
    v_add_u32 v23, v23, v25
    v_lshlrev_b32 v23, 8, v23
    v_bfe_u32 v18, v24, 4, 1
    v_lshl_add_u32 v23, v18, 5, v23
    v_and_b32 v18, 3, v24
    v_lshl_add_u32 v23, v18, 3, v23
    v_add_u32 v23, 16384, v23
    s_and_b32 s43, s40, 1
    s_lshl_b32 s43, s43, 1
    s_add_u32 s44, s43, 0
    v_xor_b32 v18, s44, v25
    v_lshl_add_u32 v15, v18, 6, v23
    s_add_u32 s44, s43, 1
    v_xor_b32 v18, s44, v25
    v_lshl_add_u32 v16, v18, 6, v23
    s_mul_i32 s44, s40, 4096
    s_add_u32 m0, s44, 0
    s_add_u32 s43, s41, 0
    buffer_load_dwordx4 v8, s[8:11], s43 offen lds
    s_mul_i32 s44, s40, 4096
    s_add_u32 m0, s44, 1024
    s_add_u32 s43, s41, 55296
    buffer_load_dwordx4 v9, s[8:11], s43 offen lds
    s_mul_i32 s44, s40, 4096
    s_add_u32 m0, s44, 2048
    s_add_u32 s43, s41, 110592
    buffer_load_dwordx4 v8, s[8:11], s43 offen lds
    s_mul_i32 s44, s40, 4096
    s_add_u32 m0, s44, 3072
    s_add_u32 s43, s41, 165888
    buffer_load_dwordx4 v9, s[8:11], s43 offen lds
    s_lshl_b32 s44, s40, 12
    s_add_u32 m0, s44, 16384
    s_mul_i32 s43, s26, 0
    s_add_u32 s43, s43, s42
    buffer_load_dwordx4 v10, s[12:15], s43 offen lds
    s_lshl_b32 s44, s40, 12
    s_add_u32 m0, s44, 17408
    s_mul_i32 s43, s26, 4
    s_add_u32 s43, s43, s42
    buffer_load_dwordx4 v10, s[12:15], s43 offen lds
    s_lshl_b32 s44, s40, 12
    s_add_u32 m0, s44, 18432
    s_mul_i32 s43, s26, 8
    s_add_u32 s43, s43, s42
    buffer_load_dwordx4 v10, s[12:15], s43 offen lds
    s_lshl_b32 s44, s40, 12
    s_add_u32 m0, s44, 19456
    s_mul_i32 s43, s26, 12
    s_add_u32 s43, s43, s42
    buffer_load_dwordx4 v10, s[12:15], s43 offen lds
    s_mul_i32 s44, s40, 4096
    s_add_u32 m0, s44, 32768
    s_add_u32 s43, s41, 128
    buffer_load_dwordx4 v8, s[8:11], s43 offen lds
    s_mul_i32 s44, s40, 4096
    s_add_u32 m0, s44, 33792
    s_add_u32 s43, s41, 55424
    buffer_load_dwordx4 v9, s[8:11], s43 offen lds
    s_mul_i32 s44, s40, 4096
    s_add_u32 m0, s44, 34816
    s_add_u32 s43, s41, 110720
    buffer_load_dwordx4 v8, s[8:11], s43 offen lds
    s_mul_i32 s44, s40, 4096
    s_add_u32 m0, s44, 35840
    s_add_u32 s43, s41, 166016
    buffer_load_dwordx4 v9, s[8:11], s43 offen lds
    s_lshl_b32 s44, s40, 12
    s_add_u32 m0, s44, 49152
    s_mul_i32 s43, s26, 64
    s_add_u32 s43, s43, s42
    buffer_load_dwordx4 v10, s[12:15], s43 offen lds
    s_lshl_b32 s44, s40, 12
    s_add_u32 m0, s44, 50176
    s_mul_i32 s43, s26, 68
    s_add_u32 s43, s43, s42
    buffer_load_dwordx4 v10, s[12:15], s43 offen lds
    s_lshl_b32 s44, s40, 12
    s_add_u32 m0, s44, 51200
    s_mul_i32 s43, s26, 72
    s_add_u32 s43, s43, s42
    buffer_load_dwordx4 v10, s[12:15], s43 offen lds
    s_lshl_b32 s44, s40, 12
    s_add_u32 m0, s44, 52224
    s_mul_i32 s43, s26, 76
    s_add_u32 s43, s43, s42
    buffer_load_dwordx4 v10, s[12:15], s43 offen lds
    s_mul_i32 s44, s40, 4096
    s_add_u32 m0, s44, 65536
    s_add_u32 s43, s41, 256
    buffer_load_dwordx4 v8, s[8:11], s43 offen lds
    s_mul_i32 s44, s40, 4096
    s_add_u32 m0, s44, 66560
    s_add_u32 s43, s41, 55552
    buffer_load_dwordx4 v9, s[8:11], s43 offen lds
    s_mul_i32 s44, s40, 4096
    s_add_u32 m0, s44, 67584
    s_add_u32 s43, s41, 110848
    buffer_load_dwordx4 v8, s[8:11], s43 offen lds
    s_mul_i32 s44, s40, 4096
    s_add_u32 m0, s44, 68608
    s_add_u32 s43, s41, 166144
    buffer_load_dwordx4 v9, s[8:11], s43 offen lds
    s_lshl_b32 s44, s40, 12
    s_add_u32 m0, s44, 81920
    s_mul_i32 s43, s26, 128
    s_add_u32 s43, s43, s42
    buffer_load_dwordx4 v10, s[12:15], s43 offen lds
    s_lshl_b32 s44, s40, 12
    s_add_u32 m0, s44, 82944
    s_mul_i32 s43, s26, 132
    s_add_u32 s43, s43, s42
    buffer_load_dwordx4 v10, s[12:15], s43 offen lds
    s_lshl_b32 s44, s40, 12
    s_add_u32 m0, s44, 83968
    s_mul_i32 s43, s26, 136
    s_add_u32 s43, s43, s42
    buffer_load_dwordx4 v10, s[12:15], s43 offen lds
    s_lshl_b32 s44, s40, 12
    s_add_u32 m0, s44, 84992
    s_mul_i32 s43, s26, 140
    s_add_u32 s43, s43, s42
    buffer_load_dwordx4 v10, s[12:15], s43 offen lds
    s_waitcnt vmcnt(16)
    s_barrier
    v_add_u32 v17, 0, v11
    v_add_u32 v18, 0, v12
    v_add_u32 v19, 0, v13
    v_add_u32 v20, 0, v14
    v_add_u32 v21, 0, v15
    v_add_u32 v22, 0, v16
    ds_read_b128 v[28:31], v17 offset:0
    ds_read_b128 v[32:35], v17 offset:4096
    ds_read_b64_tr_b16 v[44:45], v21 offset:0
    ds_read_b64_tr_b16 v[46:47], v21 offset:1024
    ds_read_b64_tr_b16 v[48:49], v22 offset:0
    ds_read_b64_tr_b16 v[50:51], v22 offset:1024
    ds_read_b128 v[36:39], v18 offset:0
    ds_read_b128 v[40:43], v18 offset:4096
    ds_read_b64_tr_b16 v[52:53], v21 offset:4096
    ds_read_b64_tr_b16 v[54:55], v21 offset:5120
    ds_read_b64_tr_b16 v[56:57], v22 offset:4096
    ds_read_b64_tr_b16 v[58:59], v22 offset:5120
    s_waitcnt lgkmcnt(6)
    v_mfma_f32_32x32x16_bf16 a[0:15], v[44:47], v[28:31], 0
    v_mfma_f32_32x32x16_bf16 a[16:31], v[48:51], v[28:31], 0
    v_mfma_f32_32x32x16_bf16 a[32:47], v[44:47], v[32:35], 0
    v_mfma_f32_32x32x16_bf16 a[48:63], v[48:51], v[32:35], 0
    ds_read_b128 v[28:31], v19 offset:0
    ds_read_b128 v[32:35], v19 offset:4096
    ds_read_b64_tr_b16 v[44:45], v21 offset:8192
    ds_read_b64_tr_b16 v[46:47], v21 offset:9216
    ds_read_b64_tr_b16 v[48:49], v22 offset:8192
    ds_read_b64_tr_b16 v[50:51], v22 offset:9216
    s_waitcnt lgkmcnt(6)
    v_mfma_f32_32x32x16_bf16 a[0:15], v[52:55], v[36:39], a[0:15]
    v_mfma_f32_32x32x16_bf16 a[16:31], v[56:59], v[36:39], a[16:31]
    v_mfma_f32_32x32x16_bf16 a[32:47], v[52:55], v[40:43], a[32:47]
    v_mfma_f32_32x32x16_bf16 a[48:63], v[56:59], v[40:43], a[48:63]
    ds_read_b128 v[36:39], v20 offset:0
    ds_read_b128 v[40:43], v20 offset:4096
    ds_read_b64_tr_b16 v[52:53], v21 offset:12288
    ds_read_b64_tr_b16 v[54:55], v21 offset:13312
    ds_read_b64_tr_b16 v[56:57], v22 offset:12288
    ds_read_b64_tr_b16 v[58:59], v22 offset:13312
    s_waitcnt lgkmcnt(6)
    v_mfma_f32_32x32x16_bf16 a[0:15], v[44:47], v[28:31], a[0:15]
    v_mfma_f32_32x32x16_bf16 a[16:31], v[48:51], v[28:31], a[16:31]
    v_mfma_f32_32x32x16_bf16 a[32:47], v[44:47], v[32:35], a[32:47]
    v_mfma_f32_32x32x16_bf16 a[48:63], v[48:51], v[32:35], a[48:63]
    s_waitcnt lgkmcnt(0)
    s_waitcnt vmcnt(8)
    s_barrier
    s_mul_i32 s44, s40, 4096
    s_add_u32 m0, s44, 0
    s_add_u32 s43, s41, 384
    buffer_load_dwordx4 v8, s[8:11], s43 offen lds
    s_mul_i32 s44, s40, 4096
    s_add_u32 m0, s44, 1024
    s_add_u32 s43, s41, 55680
    buffer_load_dwordx4 v9, s[8:11], s43 offen lds
    s_mul_i32 s44, s40, 4096
    s_add_u32 m0, s44, 2048
    s_add_u32 s43, s41, 110976
    buffer_load_dwordx4 v8, s[8:11], s43 offen lds
    s_mul_i32 s44, s40, 4096
    s_add_u32 m0, s44, 3072
    s_add_u32 s43, s41, 166272
    buffer_load_dwordx4 v9, s[8:11], s43 offen lds
    s_lshl_b32 s44, s40, 12
    s_add_u32 m0, s44, 16384
    s_mul_i32 s43, s26, 192
    s_add_u32 s43, s43, s42
    buffer_load_dwordx4 v10, s[12:15], s43 offen lds
    s_lshl_b32 s44, s40, 12
    s_add_u32 m0, s44, 17408
    s_mul_i32 s43, s26, 196
    s_add_u32 s43, s43, s42
    buffer_load_dwordx4 v10, s[12:15], s43 offen lds
    s_lshl_b32 s44, s40, 12
    s_add_u32 m0, s44, 18432
    s_mul_i32 s43, s26, 200
    s_add_u32 s43, s43, s42
    buffer_load_dwordx4 v10, s[12:15], s43 offen lds
    s_lshl_b32 s44, s40, 12
    s_add_u32 m0, s44, 19456
    s_mul_i32 s43, s26, 204
    s_add_u32 s43, s43, s42
    buffer_load_dwordx4 v10, s[12:15], s43 offen lds
    v_add_u32 v17, 32768, v11
    v_add_u32 v18, 32768, v12
    v_add_u32 v19, 32768, v13
    v_add_u32 v20, 32768, v14
    v_add_u32 v21, 32768, v15
    v_add_u32 v22, 32768, v16
    ds_read_b128 v[28:31], v17 offset:0
    ds_read_b128 v[32:35], v17 offset:4096
    ds_read_b64_tr_b16 v[44:45], v21 offset:0
    ds_read_b64_tr_b16 v[46:47], v21 offset:1024
    ds_read_b64_tr_b16 v[48:49], v22 offset:0
    ds_read_b64_tr_b16 v[50:51], v22 offset:1024
    v_mfma_f32_32x32x16_bf16 a[0:15], v[52:55], v[36:39], a[0:15]
    v_mfma_f32_32x32x16_bf16 a[16:31], v[56:59], v[36:39], a[16:31]
    v_mfma_f32_32x32x16_bf16 a[32:47], v[52:55], v[40:43], a[32:47]
    v_mfma_f32_32x32x16_bf16 a[48:63], v[56:59], v[40:43], a[48:63]
    ds_read_b128 v[36:39], v18 offset:0
    ds_read_b128 v[40:43], v18 offset:4096
    ds_read_b64_tr_b16 v[52:53], v21 offset:4096
    ds_read_b64_tr_b16 v[54:55], v21 offset:5120
    ds_read_b64_tr_b16 v[56:57], v22 offset:4096
    ds_read_b64_tr_b16 v[58:59], v22 offset:5120
    s_waitcnt lgkmcnt(6)
    v_mfma_f32_32x32x16_bf16 a[0:15], v[44:47], v[28:31], a[0:15]
    v_mfma_f32_32x32x16_bf16 a[16:31], v[48:51], v[28:31], a[16:31]
    v_mfma_f32_32x32x16_bf16 a[32:47], v[44:47], v[32:35], a[32:47]
    v_mfma_f32_32x32x16_bf16 a[48:63], v[48:51], v[32:35], a[48:63]
    ds_read_b128 v[28:31], v19 offset:0
    ds_read_b128 v[32:35], v19 offset:4096
    ds_read_b64_tr_b16 v[44:45], v21 offset:8192
    ds_read_b64_tr_b16 v[46:47], v21 offset:9216
    ds_read_b64_tr_b16 v[48:49], v22 offset:8192
    ds_read_b64_tr_b16 v[50:51], v22 offset:9216
    s_waitcnt lgkmcnt(6)
    v_mfma_f32_32x32x16_bf16 a[0:15], v[52:55], v[36:39], a[0:15]
    v_mfma_f32_32x32x16_bf16 a[16:31], v[56:59], v[36:39], a[16:31]
    v_mfma_f32_32x32x16_bf16 a[32:47], v[52:55], v[40:43], a[32:47]
    v_mfma_f32_32x32x16_bf16 a[48:63], v[56:59], v[40:43], a[48:63]
    ds_read_b128 v[36:39], v20 offset:0
    ds_read_b128 v[40:43], v20 offset:4096
    ds_read_b64_tr_b16 v[52:53], v21 offset:12288
    ds_read_b64_tr_b16 v[54:55], v21 offset:13312
    ds_read_b64_tr_b16 v[56:57], v22 offset:12288
    ds_read_b64_tr_b16 v[58:59], v22 offset:13312
    s_waitcnt lgkmcnt(6)
    v_mfma_f32_32x32x16_bf16 a[0:15], v[44:47], v[28:31], a[0:15]
    v_mfma_f32_32x32x16_bf16 a[16:31], v[48:51], v[28:31], a[16:31]
    v_mfma_f32_32x32x16_bf16 a[32:47], v[44:47], v[32:35], a[32:47]
    v_mfma_f32_32x32x16_bf16 a[48:63], v[48:51], v[32:35], a[48:63]
    s_waitcnt lgkmcnt(0)
    s_waitcnt vmcnt(8)
    s_barrier
    s_mul_i32 s44, s40, 4096
    s_add_u32 m0, s44, 32768
    s_add_u32 s43, s41, 512
    buffer_load_dwordx4 v8, s[8:11], s43 offen lds
    s_mul_i32 s44, s40, 4096
    s_add_u32 m0, s44, 33792
    s_add_u32 s43, s41, 55808
    buffer_load_dwordx4 v9, s[8:11], s43 offen lds
    s_mul_i32 s44, s40, 4096
    s_add_u32 m0, s44, 34816
    s_add_u32 s43, s41, 111104
    buffer_load_dwordx4 v8, s[8:11], s43 offen lds
    s_mul_i32 s44, s40, 4096
    s_add_u32 m0, s44, 35840
    s_add_u32 s43, s41, 166400
    buffer_load_dwordx4 v9, s[8:11], s43 offen lds
    s_lshl_b32 s44, s40, 12
    s_add_u32 m0, s44, 49152
    s_mul_i32 s43, s26, 256
    s_add_u32 s43, s43, s42
    buffer_load_dwordx4 v10, s[12:15], s43 offen lds
    s_lshl_b32 s44, s40, 12
    s_add_u32 m0, s44, 50176
    s_mul_i32 s43, s26, 260
    s_add_u32 s43, s43, s42
    buffer_load_dwordx4 v10, s[12:15], s43 offen lds
    s_lshl_b32 s44, s40, 12
    s_add_u32 m0, s44, 51200
    s_mul_i32 s43, s26, 264
    s_add_u32 s43, s43, s42
    buffer_load_dwordx4 v10, s[12:15], s43 offen lds
    s_lshl_b32 s44, s40, 12
    s_add_u32 m0, s44, 52224
    s_mul_i32 s43, s26, 268
    s_add_u32 s43, s43, s42
    buffer_load_dwordx4 v10, s[12:15], s43 offen lds
    v_add_u32 v17, 65536, v11
    v_add_u32 v18, 65536, v12
    v_add_u32 v19, 65536, v13
    v_add_u32 v20, 65536, v14
    v_add_u32 v21, 65536, v15
    v_add_u32 v22, 65536, v16
    ds_read_b128 v[28:31], v17 offset:0
    ds_read_b128 v[32:35], v17 offset:4096
    ds_read_b64_tr_b16 v[44:45], v21 offset:0
    ds_read_b64_tr_b16 v[46:47], v21 offset:1024
    ds_read_b64_tr_b16 v[48:49], v22 offset:0
    ds_read_b64_tr_b16 v[50:51], v22 offset:1024
    v_mfma_f32_32x32x16_bf16 a[0:15], v[52:55], v[36:39], a[0:15]
    v_mfma_f32_32x32x16_bf16 a[16:31], v[56:59], v[36:39], a[16:31]
    v_mfma_f32_32x32x16_bf16 a[32:47], v[52:55], v[40:43], a[32:47]
    v_mfma_f32_32x32x16_bf16 a[48:63], v[56:59], v[40:43], a[48:63]
    ds_read_b128 v[36:39], v18 offset:0
    ds_read_b128 v[40:43], v18 offset:4096
    ds_read_b64_tr_b16 v[52:53], v21 offset:4096
    ds_read_b64_tr_b16 v[54:55], v21 offset:5120
    ds_read_b64_tr_b16 v[56:57], v22 offset:4096
    ds_read_b64_tr_b16 v[58:59], v22 offset:5120
    s_waitcnt lgkmcnt(6)
    v_mfma_f32_32x32x16_bf16 a[0:15], v[44:47], v[28:31], a[0:15]
    v_mfma_f32_32x32x16_bf16 a[16:31], v[48:51], v[28:31], a[16:31]
    v_mfma_f32_32x32x16_bf16 a[32:47], v[44:47], v[32:35], a[32:47]
    v_mfma_f32_32x32x16_bf16 a[48:63], v[48:51], v[32:35], a[48:63]
    ds_read_b128 v[28:31], v19 offset:0
    ds_read_b128 v[32:35], v19 offset:4096
    ds_read_b64_tr_b16 v[44:45], v21 offset:8192
    ds_read_b64_tr_b16 v[46:47], v21 offset:9216
    ds_read_b64_tr_b16 v[48:49], v22 offset:8192
    ds_read_b64_tr_b16 v[50:51], v22 offset:9216
    s_waitcnt lgkmcnt(6)
    v_mfma_f32_32x32x16_bf16 a[0:15], v[52:55], v[36:39], a[0:15]
    v_mfma_f32_32x32x16_bf16 a[16:31], v[56:59], v[36:39], a[16:31]
    v_mfma_f32_32x32x16_bf16 a[32:47], v[52:55], v[40:43], a[32:47]
    v_mfma_f32_32x32x16_bf16 a[48:63], v[56:59], v[40:43], a[48:63]
    ds_read_b128 v[36:39], v20 offset:0
    ds_read_b128 v[40:43], v20 offset:4096
    ds_read_b64_tr_b16 v[52:53], v21 offset:12288
    ds_read_b64_tr_b16 v[54:55], v21 offset:13312
    ds_read_b64_tr_b16 v[56:57], v22 offset:12288
    ds_read_b64_tr_b16 v[58:59], v22 offset:13312
    s_waitcnt lgkmcnt(6)
    v_mfma_f32_32x32x16_bf16 a[0:15], v[44:47], v[28:31], a[0:15]
    v_mfma_f32_32x32x16_bf16 a[16:31], v[48:51], v[28:31], a[16:31]
    v_mfma_f32_32x32x16_bf16 a[32:47], v[44:47], v[32:35], a[32:47]
    v_mfma_f32_32x32x16_bf16 a[48:63], v[48:51], v[32:35], a[48:63]
    s_waitcnt lgkmcnt(0)
    s_waitcnt vmcnt(8)
    s_barrier
    s_mul_i32 s44, s40, 4096
    s_add_u32 m0, s44, 65536
    s_add_u32 s43, s41, 640
    buffer_load_dwordx4 v8, s[8:11], s43 offen lds
    s_mul_i32 s44, s40, 4096
    s_add_u32 m0, s44, 66560
    s_add_u32 s43, s41, 55936
    buffer_load_dwordx4 v9, s[8:11], s43 offen lds
    s_mul_i32 s44, s40, 4096
    s_add_u32 m0, s44, 67584
    s_add_u32 s43, s41, 111232
    buffer_load_dwordx4 v8, s[8:11], s43 offen lds
    s_mul_i32 s44, s40, 4096
    s_add_u32 m0, s44, 68608
    s_add_u32 s43, s41, 166528
    buffer_load_dwordx4 v9, s[8:11], s43 offen lds
    s_lshl_b32 s44, s40, 12
    s_add_u32 m0, s44, 81920
    s_mul_i32 s43, s26, 320
    s_add_u32 s43, s43, s42
    buffer_load_dwordx4 v10, s[12:15], s43 offen lds
    s_lshl_b32 s44, s40, 12
    s_add_u32 m0, s44, 82944
    s_mul_i32 s43, s26, 324
    s_add_u32 s43, s43, s42
    buffer_load_dwordx4 v10, s[12:15], s43 offen lds
    s_lshl_b32 s44, s40, 12
    s_add_u32 m0, s44, 83968
    s_mul_i32 s43, s26, 328
    s_add_u32 s43, s43, s42
    buffer_load_dwordx4 v10, s[12:15], s43 offen lds
    s_lshl_b32 s44, s40, 12
    s_add_u32 m0, s44, 84992
    s_mul_i32 s43, s26, 332
    s_add_u32 s43, s43, s42
    buffer_load_dwordx4 v10, s[12:15], s43 offen lds
    v_add_u32 v17, 0, v11
    v_add_u32 v18, 0, v12
    v_add_u32 v19, 0, v13
    v_add_u32 v20, 0, v14
    v_add_u32 v21, 0, v15
    v_add_u32 v22, 0, v16
    ds_read_b128 v[28:31], v17 offset:0
    ds_read_b128 v[32:35], v17 offset:4096
    ds_read_b64_tr_b16 v[44:45], v21 offset:0
    ds_read_b64_tr_b16 v[46:47], v21 offset:1024
    ds_read_b64_tr_b16 v[48:49], v22 offset:0
    ds_read_b64_tr_b16 v[50:51], v22 offset:1024
    v_mfma_f32_32x32x16_bf16 a[0:15], v[52:55], v[36:39], a[0:15]
    v_mfma_f32_32x32x16_bf16 a[16:31], v[56:59], v[36:39], a[16:31]
    v_mfma_f32_32x32x16_bf16 a[32:47], v[52:55], v[40:43], a[32:47]
    v_mfma_f32_32x32x16_bf16 a[48:63], v[56:59], v[40:43], a[48:63]
    ds_read_b128 v[36:39], v18 offset:0
    ds_read_b128 v[40:43], v18 offset:4096
    ds_read_b64_tr_b16 v[52:53], v21 offset:4096
    ds_read_b64_tr_b16 v[54:55], v21 offset:5120
    ds_read_b64_tr_b16 v[56:57], v22 offset:4096
    ds_read_b64_tr_b16 v[58:59], v22 offset:5120
    s_waitcnt lgkmcnt(6)
    v_mfma_f32_32x32x16_bf16 a[0:15], v[44:47], v[28:31], a[0:15]
    v_mfma_f32_32x32x16_bf16 a[16:31], v[48:51], v[28:31], a[16:31]
    v_mfma_f32_32x32x16_bf16 a[32:47], v[44:47], v[32:35], a[32:47]
    v_mfma_f32_32x32x16_bf16 a[48:63], v[48:51], v[32:35], a[48:63]
    ds_read_b128 v[28:31], v19 offset:0
    ds_read_b128 v[32:35], v19 offset:4096
    ds_read_b64_tr_b16 v[44:45], v21 offset:8192
    ds_read_b64_tr_b16 v[46:47], v21 offset:9216
    ds_read_b64_tr_b16 v[48:49], v22 offset:8192
    ds_read_b64_tr_b16 v[50:51], v22 offset:9216
    s_waitcnt lgkmcnt(6)
    v_mfma_f32_32x32x16_bf16 a[0:15], v[52:55], v[36:39], a[0:15]
    v_mfma_f32_32x32x16_bf16 a[16:31], v[56:59], v[36:39], a[16:31]
    v_mfma_f32_32x32x16_bf16 a[32:47], v[52:55], v[40:43], a[32:47]
    v_mfma_f32_32x32x16_bf16 a[48:63], v[56:59], v[40:43], a[48:63]
    ds_read_b128 v[36:39], v20 offset:0
    ds_read_b128 v[40:43], v20 offset:4096
    ds_read_b64_tr_b16 v[52:53], v21 offset:12288
    ds_read_b64_tr_b16 v[54:55], v21 offset:13312
    ds_read_b64_tr_b16 v[56:57], v22 offset:12288
    ds_read_b64_tr_b16 v[58:59], v22 offset:13312
    s_waitcnt lgkmcnt(6)
    v_mfma_f32_32x32x16_bf16 a[0:15], v[44:47], v[28:31], a[0:15]
    v_mfma_f32_32x32x16_bf16 a[16:31], v[48:51], v[28:31], a[16:31]
    v_mfma_f32_32x32x16_bf16 a[32:47], v[44:47], v[32:35], a[32:47]
    v_mfma_f32_32x32x16_bf16 a[48:63], v[48:51], v[32:35], a[48:63]
    s_waitcnt lgkmcnt(0)
    s_waitcnt vmcnt(8)
    s_barrier
    s_mul_i32 s44, s40, 4096
    s_add_u32 m0, s44, 0
    s_add_u32 s43, s41, 768
    buffer_load_dwordx4 v8, s[8:11], s43 offen lds
    s_mul_i32 s44, s40, 4096
    s_add_u32 m0, s44, 1024
    s_add_u32 s43, s41, 56064
    buffer_load_dwordx4 v9, s[8:11], s43 offen lds
    s_mul_i32 s44, s40, 4096
    s_add_u32 m0, s44, 2048
    s_add_u32 s43, s41, 111360
    buffer_load_dwordx4 v8, s[8:11], s43 offen lds
    s_mul_i32 s44, s40, 4096
    s_add_u32 m0, s44, 3072
    s_add_u32 s43, s41, 166656
    buffer_load_dwordx4 v9, s[8:11], s43 offen lds
    s_lshl_b32 s44, s40, 12
    s_add_u32 m0, s44, 16384
    s_mul_i32 s43, s26, 384
    s_add_u32 s43, s43, s42
    buffer_load_dwordx4 v10, s[12:15], s43 offen lds
    s_lshl_b32 s44, s40, 12
    s_add_u32 m0, s44, 17408
    s_mul_i32 s43, s26, 388
    s_add_u32 s43, s43, s42
    buffer_load_dwordx4 v10, s[12:15], s43 offen lds
    s_lshl_b32 s44, s40, 12
    s_add_u32 m0, s44, 18432
    s_mul_i32 s43, s26, 392
    s_add_u32 s43, s43, s42
    buffer_load_dwordx4 v10, s[12:15], s43 offen lds
    s_lshl_b32 s44, s40, 12
    s_add_u32 m0, s44, 19456
    s_mul_i32 s43, s26, 396
    s_add_u32 s43, s43, s42
    buffer_load_dwordx4 v10, s[12:15], s43 offen lds
    v_add_u32 v17, 32768, v11
    v_add_u32 v18, 32768, v12
    v_add_u32 v19, 32768, v13
    v_add_u32 v20, 32768, v14
    v_add_u32 v21, 32768, v15
    v_add_u32 v22, 32768, v16
    ds_read_b128 v[28:31], v17 offset:0
    ds_read_b128 v[32:35], v17 offset:4096
    ds_read_b64_tr_b16 v[44:45], v21 offset:0
    ds_read_b64_tr_b16 v[46:47], v21 offset:1024
    ds_read_b64_tr_b16 v[48:49], v22 offset:0
    ds_read_b64_tr_b16 v[50:51], v22 offset:1024
    v_mfma_f32_32x32x16_bf16 a[0:15], v[52:55], v[36:39], a[0:15]
    v_mfma_f32_32x32x16_bf16 a[16:31], v[56:59], v[36:39], a[16:31]
    v_mfma_f32_32x32x16_bf16 a[32:47], v[52:55], v[40:43], a[32:47]
    v_mfma_f32_32x32x16_bf16 a[48:63], v[56:59], v[40:43], a[48:63]
    ds_read_b128 v[36:39], v18 offset:0
    ds_read_b128 v[40:43], v18 offset:4096
    ds_read_b64_tr_b16 v[52:53], v21 offset:4096
    ds_read_b64_tr_b16 v[54:55], v21 offset:5120
    ds_read_b64_tr_b16 v[56:57], v22 offset:4096
    ds_read_b64_tr_b16 v[58:59], v22 offset:5120
    s_waitcnt lgkmcnt(6)
    v_mfma_f32_32x32x16_bf16 a[0:15], v[44:47], v[28:31], a[0:15]
    v_mfma_f32_32x32x16_bf16 a[16:31], v[48:51], v[28:31], a[16:31]
    v_mfma_f32_32x32x16_bf16 a[32:47], v[44:47], v[32:35], a[32:47]
    v_mfma_f32_32x32x16_bf16 a[48:63], v[48:51], v[32:35], a[48:63]
    ds_read_b128 v[28:31], v19 offset:0
    ds_read_b128 v[32:35], v19 offset:4096
    ds_read_b64_tr_b16 v[44:45], v21 offset:8192
    ds_read_b64_tr_b16 v[46:47], v21 offset:9216
    ds_read_b64_tr_b16 v[48:49], v22 offset:8192
    ds_read_b64_tr_b16 v[50:51], v22 offset:9216
    s_waitcnt lgkmcnt(6)
    v_mfma_f32_32x32x16_bf16 a[0:15], v[52:55], v[36:39], a[0:15]
    v_mfma_f32_32x32x16_bf16 a[16:31], v[56:59], v[36:39], a[16:31]
    v_mfma_f32_32x32x16_bf16 a[32:47], v[52:55], v[40:43], a[32:47]
    v_mfma_f32_32x32x16_bf16 a[48:63], v[56:59], v[40:43], a[48:63]
    ds_read_b128 v[36:39], v20 offset:0
    ds_read_b128 v[40:43], v20 offset:4096
    ds_read_b64_tr_b16 v[52:53], v21 offset:12288
    ds_read_b64_tr_b16 v[54:55], v21 offset:13312
    ds_read_b64_tr_b16 v[56:57], v22 offset:12288
    ds_read_b64_tr_b16 v[58:59], v22 offset:13312
    s_waitcnt lgkmcnt(6)
    v_mfma_f32_32x32x16_bf16 a[0:15], v[44:47], v[28:31], a[0:15]
    v_mfma_f32_32x32x16_bf16 a[16:31], v[48:51], v[28:31], a[16:31]
    v_mfma_f32_32x32x16_bf16 a[32:47], v[44:47], v[32:35], a[32:47]
    v_mfma_f32_32x32x16_bf16 a[48:63], v[48:51], v[32:35], a[48:63]
    s_waitcnt lgkmcnt(0)
    s_waitcnt vmcnt(8)
    s_barrier
    s_mul_i32 s44, s40, 4096
    s_add_u32 m0, s44, 32768
    s_add_u32 s43, s41, 896
    buffer_load_dwordx4 v8, s[8:11], s43 offen lds
    s_mul_i32 s44, s40, 4096
    s_add_u32 m0, s44, 33792
    s_add_u32 s43, s41, 56192
    buffer_load_dwordx4 v9, s[8:11], s43 offen lds
    s_mul_i32 s44, s40, 4096
    s_add_u32 m0, s44, 34816
    s_add_u32 s43, s41, 111488
    buffer_load_dwordx4 v8, s[8:11], s43 offen lds
    s_mul_i32 s44, s40, 4096
    s_add_u32 m0, s44, 35840
    s_add_u32 s43, s41, 166784
    buffer_load_dwordx4 v9, s[8:11], s43 offen lds
    s_lshl_b32 s44, s40, 12
    s_add_u32 m0, s44, 49152
    s_mul_i32 s43, s26, 448
    s_add_u32 s43, s43, s42
    buffer_load_dwordx4 v10, s[12:15], s43 offen lds
    s_lshl_b32 s44, s40, 12
    s_add_u32 m0, s44, 50176
    s_mul_i32 s43, s26, 452
    s_add_u32 s43, s43, s42
    buffer_load_dwordx4 v10, s[12:15], s43 offen lds
    s_lshl_b32 s44, s40, 12
    s_add_u32 m0, s44, 51200
    s_mul_i32 s43, s26, 456
    s_add_u32 s43, s43, s42
    buffer_load_dwordx4 v10, s[12:15], s43 offen lds
    s_lshl_b32 s44, s40, 12
    s_add_u32 m0, s44, 52224
    s_mul_i32 s43, s26, 460
    s_add_u32 s43, s43, s42
    buffer_load_dwordx4 v10, s[12:15], s43 offen lds
    v_add_u32 v17, 65536, v11
    v_add_u32 v18, 65536, v12
    v_add_u32 v19, 65536, v13
    v_add_u32 v20, 65536, v14
    v_add_u32 v21, 65536, v15
    v_add_u32 v22, 65536, v16
    ds_read_b128 v[28:31], v17 offset:0
    ds_read_b128 v[32:35], v17 offset:4096
    ds_read_b64_tr_b16 v[44:45], v21 offset:0
    ds_read_b64_tr_b16 v[46:47], v21 offset:1024
    ds_read_b64_tr_b16 v[48:49], v22 offset:0
    ds_read_b64_tr_b16 v[50:51], v22 offset:1024
    v_mfma_f32_32x32x16_bf16 a[0:15], v[52:55], v[36:39], a[0:15]
    v_mfma_f32_32x32x16_bf16 a[16:31], v[56:59], v[36:39], a[16:31]
    v_mfma_f32_32x32x16_bf16 a[32:47], v[52:55], v[40:43], a[32:47]
    v_mfma_f32_32x32x16_bf16 a[48:63], v[56:59], v[40:43], a[48:63]
    ds_read_b128 v[36:39], v18 offset:0
    ds_read_b128 v[40:43], v18 offset:4096
    ds_read_b64_tr_b16 v[52:53], v21 offset:4096
    ds_read_b64_tr_b16 v[54:55], v21 offset:5120
    ds_read_b64_tr_b16 v[56:57], v22 offset:4096
    ds_read_b64_tr_b16 v[58:59], v22 offset:5120
    s_waitcnt lgkmcnt(6)
    v_mfma_f32_32x32x16_bf16 a[0:15], v[44:47], v[28:31], a[0:15]
    v_mfma_f32_32x32x16_bf16 a[16:31], v[48:51], v[28:31], a[16:31]
    v_mfma_f32_32x32x16_bf16 a[32:47], v[44:47], v[32:35], a[32:47]
    v_mfma_f32_32x32x16_bf16 a[48:63], v[48:51], v[32:35], a[48:63]
    ds_read_b128 v[28:31], v19 offset:0
    ds_read_b128 v[32:35], v19 offset:4096
    ds_read_b64_tr_b16 v[44:45], v21 offset:8192
    ds_read_b64_tr_b16 v[46:47], v21 offset:9216
    ds_read_b64_tr_b16 v[48:49], v22 offset:8192
    ds_read_b64_tr_b16 v[50:51], v22 offset:9216
    s_waitcnt lgkmcnt(6)
    v_mfma_f32_32x32x16_bf16 a[0:15], v[52:55], v[36:39], a[0:15]
    v_mfma_f32_32x32x16_bf16 a[16:31], v[56:59], v[36:39], a[16:31]
    v_mfma_f32_32x32x16_bf16 a[32:47], v[52:55], v[40:43], a[32:47]
    v_mfma_f32_32x32x16_bf16 a[48:63], v[56:59], v[40:43], a[48:63]
    ds_read_b128 v[36:39], v20 offset:0
    ds_read_b128 v[40:43], v20 offset:4096
    ds_read_b64_tr_b16 v[52:53], v21 offset:12288
    ds_read_b64_tr_b16 v[54:55], v21 offset:13312
    ds_read_b64_tr_b16 v[56:57], v22 offset:12288
    ds_read_b64_tr_b16 v[58:59], v22 offset:13312
    s_waitcnt lgkmcnt(6)
    v_mfma_f32_32x32x16_bf16 a[0:15], v[44:47], v[28:31], a[0:15]
    v_mfma_f32_32x32x16_bf16 a[16:31], v[48:51], v[28:31], a[16:31]
    v_mfma_f32_32x32x16_bf16 a[32:47], v[44:47], v[32:35], a[32:47]
    v_mfma_f32_32x32x16_bf16 a[48:63], v[48:51], v[32:35], a[48:63]
    s_waitcnt lgkmcnt(0)
    s_waitcnt vmcnt(8)
    s_barrier
    s_mul_i32 s44, s40, 4096
    s_add_u32 m0, s44, 65536
    s_add_u32 s43, s41, 1024
    buffer_load_dwordx4 v8, s[8:11], s43 offen lds
    s_mul_i32 s44, s40, 4096
    s_add_u32 m0, s44, 66560
    s_add_u32 s43, s41, 56320
    buffer_load_dwordx4 v9, s[8:11], s43 offen lds
    s_mul_i32 s44, s40, 4096
    s_add_u32 m0, s44, 67584
    s_add_u32 s43, s41, 111616
    buffer_load_dwordx4 v8, s[8:11], s43 offen lds
    s_mul_i32 s44, s40, 4096
    s_add_u32 m0, s44, 68608
    s_add_u32 s43, s41, 166912
    buffer_load_dwordx4 v9, s[8:11], s43 offen lds
    s_lshl_b32 s44, s40, 12
    s_add_u32 m0, s44, 81920
    s_mul_i32 s43, s26, 512
    s_add_u32 s43, s43, s42
    buffer_load_dwordx4 v10, s[12:15], s43 offen lds
    s_lshl_b32 s44, s40, 12
    s_add_u32 m0, s44, 82944
    s_mul_i32 s43, s26, 516
    s_add_u32 s43, s43, s42
    buffer_load_dwordx4 v10, s[12:15], s43 offen lds
    s_lshl_b32 s44, s40, 12
    s_add_u32 m0, s44, 83968
    s_mul_i32 s43, s26, 520
    s_add_u32 s43, s43, s42
    buffer_load_dwordx4 v10, s[12:15], s43 offen lds
    s_lshl_b32 s44, s40, 12
    s_add_u32 m0, s44, 84992
    s_mul_i32 s43, s26, 524
    s_add_u32 s43, s43, s42
    buffer_load_dwordx4 v10, s[12:15], s43 offen lds
    v_add_u32 v17, 0, v11
    v_add_u32 v18, 0, v12
    v_add_u32 v19, 0, v13
    v_add_u32 v20, 0, v14
    v_add_u32 v21, 0, v15
    v_add_u32 v22, 0, v16
    ds_read_b128 v[28:31], v17 offset:0
    ds_read_b128 v[32:35], v17 offset:4096
    ds_read_b64_tr_b16 v[44:45], v21 offset:0
    ds_read_b64_tr_b16 v[46:47], v21 offset:1024
    ds_read_b64_tr_b16 v[48:49], v22 offset:0
    ds_read_b64_tr_b16 v[50:51], v22 offset:1024
    v_mfma_f32_32x32x16_bf16 a[0:15], v[52:55], v[36:39], a[0:15]
    v_mfma_f32_32x32x16_bf16 a[16:31], v[56:59], v[36:39], a[16:31]
    v_mfma_f32_32x32x16_bf16 a[32:47], v[52:55], v[40:43], a[32:47]
    v_mfma_f32_32x32x16_bf16 a[48:63], v[56:59], v[40:43], a[48:63]
    ds_read_b128 v[36:39], v18 offset:0
    ds_read_b128 v[40:43], v18 offset:4096
    ds_read_b64_tr_b16 v[52:53], v21 offset:4096
    ds_read_b64_tr_b16 v[54:55], v21 offset:5120
    ds_read_b64_tr_b16 v[56:57], v22 offset:4096
    ds_read_b64_tr_b16 v[58:59], v22 offset:5120
    s_waitcnt lgkmcnt(6)
    v_mfma_f32_32x32x16_bf16 a[0:15], v[44:47], v[28:31], a[0:15]
    v_mfma_f32_32x32x16_bf16 a[16:31], v[48:51], v[28:31], a[16:31]
    v_mfma_f32_32x32x16_bf16 a[32:47], v[44:47], v[32:35], a[32:47]
    v_mfma_f32_32x32x16_bf16 a[48:63], v[48:51], v[32:35], a[48:63]
    ds_read_b128 v[28:31], v19 offset:0
    ds_read_b128 v[32:35], v19 offset:4096
    ds_read_b64_tr_b16 v[44:45], v21 offset:8192
    ds_read_b64_tr_b16 v[46:47], v21 offset:9216
    ds_read_b64_tr_b16 v[48:49], v22 offset:8192
    ds_read_b64_tr_b16 v[50:51], v22 offset:9216
    s_waitcnt lgkmcnt(6)
    v_mfma_f32_32x32x16_bf16 a[0:15], v[52:55], v[36:39], a[0:15]
    v_mfma_f32_32x32x16_bf16 a[16:31], v[56:59], v[36:39], a[16:31]
    v_mfma_f32_32x32x16_bf16 a[32:47], v[52:55], v[40:43], a[32:47]
    v_mfma_f32_32x32x16_bf16 a[48:63], v[56:59], v[40:43], a[48:63]
    ds_read_b128 v[36:39], v20 offset:0
    ds_read_b128 v[40:43], v20 offset:4096
    ds_read_b64_tr_b16 v[52:53], v21 offset:12288
    ds_read_b64_tr_b16 v[54:55], v21 offset:13312
    ds_read_b64_tr_b16 v[56:57], v22 offset:12288
    ds_read_b64_tr_b16 v[58:59], v22 offset:13312
    s_waitcnt lgkmcnt(6)
    v_mfma_f32_32x32x16_bf16 a[0:15], v[44:47], v[28:31], a[0:15]
    v_mfma_f32_32x32x16_bf16 a[16:31], v[48:51], v[28:31], a[16:31]
    v_mfma_f32_32x32x16_bf16 a[32:47], v[44:47], v[32:35], a[32:47]
    v_mfma_f32_32x32x16_bf16 a[48:63], v[48:51], v[32:35], a[48:63]
    s_waitcnt lgkmcnt(0)
    s_waitcnt vmcnt(8)
    s_barrier
    s_mul_i32 s44, s40, 4096
    s_add_u32 m0, s44, 0
    s_add_u32 s43, s41, 1152
    buffer_load_dwordx4 v8, s[8:11], s43 offen lds
    s_mul_i32 s44, s40, 4096
    s_add_u32 m0, s44, 1024
    s_add_u32 s43, s41, 56448
    buffer_load_dwordx4 v9, s[8:11], s43 offen lds
    s_mul_i32 s44, s40, 4096
    s_add_u32 m0, s44, 2048
    s_add_u32 s43, s41, 111744
    buffer_load_dwordx4 v8, s[8:11], s43 offen lds
    s_mul_i32 s44, s40, 4096
    s_add_u32 m0, s44, 3072
    s_add_u32 s43, s41, 167040
    buffer_load_dwordx4 v9, s[8:11], s43 offen lds
    s_lshl_b32 s44, s40, 12
    s_add_u32 m0, s44, 16384
    s_mul_i32 s43, s26, 576
    s_add_u32 s43, s43, s42
    buffer_load_dwordx4 v10, s[12:15], s43 offen lds
    s_lshl_b32 s44, s40, 12
    s_add_u32 m0, s44, 17408
    s_mul_i32 s43, s26, 580
    s_add_u32 s43, s43, s42
    buffer_load_dwordx4 v10, s[12:15], s43 offen lds
    s_lshl_b32 s44, s40, 12
    s_add_u32 m0, s44, 18432
    s_mul_i32 s43, s26, 584
    s_add_u32 s43, s43, s42
    buffer_load_dwordx4 v10, s[12:15], s43 offen lds
    s_lshl_b32 s44, s40, 12
    s_add_u32 m0, s44, 19456
    s_mul_i32 s43, s26, 588
    s_add_u32 s43, s43, s42
    buffer_load_dwordx4 v10, s[12:15], s43 offen lds
    v_add_u32 v17, 32768, v11
    v_add_u32 v18, 32768, v12
    v_add_u32 v19, 32768, v13
    v_add_u32 v20, 32768, v14
    v_add_u32 v21, 32768, v15
    v_add_u32 v22, 32768, v16
    ds_read_b128 v[28:31], v17 offset:0
    ds_read_b128 v[32:35], v17 offset:4096
    ds_read_b64_tr_b16 v[44:45], v21 offset:0
    ds_read_b64_tr_b16 v[46:47], v21 offset:1024
    ds_read_b64_tr_b16 v[48:49], v22 offset:0
    ds_read_b64_tr_b16 v[50:51], v22 offset:1024
    v_mfma_f32_32x32x16_bf16 a[0:15], v[52:55], v[36:39], a[0:15]
    v_mfma_f32_32x32x16_bf16 a[16:31], v[56:59], v[36:39], a[16:31]
    v_mfma_f32_32x32x16_bf16 a[32:47], v[52:55], v[40:43], a[32:47]
    v_mfma_f32_32x32x16_bf16 a[48:63], v[56:59], v[40:43], a[48:63]
    ds_read_b128 v[36:39], v18 offset:0
    ds_read_b128 v[40:43], v18 offset:4096
    ds_read_b64_tr_b16 v[52:53], v21 offset:4096
    ds_read_b64_tr_b16 v[54:55], v21 offset:5120
    ds_read_b64_tr_b16 v[56:57], v22 offset:4096
    ds_read_b64_tr_b16 v[58:59], v22 offset:5120
    s_waitcnt lgkmcnt(6)
    v_mfma_f32_32x32x16_bf16 a[0:15], v[44:47], v[28:31], a[0:15]
    v_mfma_f32_32x32x16_bf16 a[16:31], v[48:51], v[28:31], a[16:31]
    v_mfma_f32_32x32x16_bf16 a[32:47], v[44:47], v[32:35], a[32:47]
    v_mfma_f32_32x32x16_bf16 a[48:63], v[48:51], v[32:35], a[48:63]
    ds_read_b128 v[28:31], v19 offset:0
    ds_read_b128 v[32:35], v19 offset:4096
    ds_read_b64_tr_b16 v[44:45], v21 offset:8192
    ds_read_b64_tr_b16 v[46:47], v21 offset:9216
    ds_read_b64_tr_b16 v[48:49], v22 offset:8192
    ds_read_b64_tr_b16 v[50:51], v22 offset:9216
    s_waitcnt lgkmcnt(6)
    v_mfma_f32_32x32x16_bf16 a[0:15], v[52:55], v[36:39], a[0:15]
    v_mfma_f32_32x32x16_bf16 a[16:31], v[56:59], v[36:39], a[16:31]
    v_mfma_f32_32x32x16_bf16 a[32:47], v[52:55], v[40:43], a[32:47]
    v_mfma_f32_32x32x16_bf16 a[48:63], v[56:59], v[40:43], a[48:63]
    ds_read_b128 v[36:39], v20 offset:0
    ds_read_b128 v[40:43], v20 offset:4096
    ds_read_b64_tr_b16 v[52:53], v21 offset:12288
    ds_read_b64_tr_b16 v[54:55], v21 offset:13312
    ds_read_b64_tr_b16 v[56:57], v22 offset:12288
    ds_read_b64_tr_b16 v[58:59], v22 offset:13312
    s_waitcnt lgkmcnt(6)
    v_mfma_f32_32x32x16_bf16 a[0:15], v[44:47], v[28:31], a[0:15]
    v_mfma_f32_32x32x16_bf16 a[16:31], v[48:51], v[28:31], a[16:31]
    v_mfma_f32_32x32x16_bf16 a[32:47], v[44:47], v[32:35], a[32:47]
    v_mfma_f32_32x32x16_bf16 a[48:63], v[48:51], v[32:35], a[48:63]
    s_waitcnt lgkmcnt(0)
    s_waitcnt vmcnt(8)
    s_barrier
    s_mul_i32 s44, s40, 4096
    s_add_u32 m0, s44, 32768
    s_add_u32 s43, s41, 1280
    buffer_load_dwordx4 v8, s[8:11], s43 offen lds
    s_mul_i32 s44, s40, 4096
    s_add_u32 m0, s44, 33792
    s_add_u32 s43, s41, 56576
    buffer_load_dwordx4 v9, s[8:11], s43 offen lds
    s_mul_i32 s44, s40, 4096
    s_add_u32 m0, s44, 34816
    s_add_u32 s43, s41, 111872
    buffer_load_dwordx4 v8, s[8:11], s43 offen lds
    s_mul_i32 s44, s40, 4096
    s_add_u32 m0, s44, 35840
    s_add_u32 s43, s41, 167168
    buffer_load_dwordx4 v9, s[8:11], s43 offen lds
    s_lshl_b32 s44, s40, 12
    s_add_u32 m0, s44, 49152
    s_mul_i32 s43, s26, 640
    s_add_u32 s43, s43, s42
    buffer_load_dwordx4 v10, s[12:15], s43 offen lds
    s_lshl_b32 s44, s40, 12
    s_add_u32 m0, s44, 50176
    s_mul_i32 s43, s26, 644
    s_add_u32 s43, s43, s42
    buffer_load_dwordx4 v10, s[12:15], s43 offen lds
    s_lshl_b32 s44, s40, 12
    s_add_u32 m0, s44, 51200
    s_mul_i32 s43, s26, 648
    s_add_u32 s43, s43, s42
    buffer_load_dwordx4 v10, s[12:15], s43 offen lds
    s_lshl_b32 s44, s40, 12
    s_add_u32 m0, s44, 52224
    s_mul_i32 s43, s26, 652
    s_add_u32 s43, s43, s42
    buffer_load_dwordx4 v10, s[12:15], s43 offen lds
    v_add_u32 v17, 65536, v11
    v_add_u32 v18, 65536, v12
    v_add_u32 v19, 65536, v13
    v_add_u32 v20, 65536, v14
    v_add_u32 v21, 65536, v15
    v_add_u32 v22, 65536, v16
    ds_read_b128 v[28:31], v17 offset:0
    ds_read_b128 v[32:35], v17 offset:4096
    ds_read_b64_tr_b16 v[44:45], v21 offset:0
    ds_read_b64_tr_b16 v[46:47], v21 offset:1024
    ds_read_b64_tr_b16 v[48:49], v22 offset:0
    ds_read_b64_tr_b16 v[50:51], v22 offset:1024
    v_mfma_f32_32x32x16_bf16 a[0:15], v[52:55], v[36:39], a[0:15]
    v_mfma_f32_32x32x16_bf16 a[16:31], v[56:59], v[36:39], a[16:31]
    v_mfma_f32_32x32x16_bf16 a[32:47], v[52:55], v[40:43], a[32:47]
    v_mfma_f32_32x32x16_bf16 a[48:63], v[56:59], v[40:43], a[48:63]
    ds_read_b128 v[36:39], v18 offset:0
    ds_read_b128 v[40:43], v18 offset:4096
    ds_read_b64_tr_b16 v[52:53], v21 offset:4096
    ds_read_b64_tr_b16 v[54:55], v21 offset:5120
    ds_read_b64_tr_b16 v[56:57], v22 offset:4096
    ds_read_b64_tr_b16 v[58:59], v22 offset:5120
    s_waitcnt lgkmcnt(6)
    v_mfma_f32_32x32x16_bf16 a[0:15], v[44:47], v[28:31], a[0:15]
    v_mfma_f32_32x32x16_bf16 a[16:31], v[48:51], v[28:31], a[16:31]
    v_mfma_f32_32x32x16_bf16 a[32:47], v[44:47], v[32:35], a[32:47]
    v_mfma_f32_32x32x16_bf16 a[48:63], v[48:51], v[32:35], a[48:63]
    ds_read_b128 v[28:31], v19 offset:0
    ds_read_b128 v[32:35], v19 offset:4096
    ds_read_b64_tr_b16 v[44:45], v21 offset:8192
    ds_read_b64_tr_b16 v[46:47], v21 offset:9216
    ds_read_b64_tr_b16 v[48:49], v22 offset:8192
    ds_read_b64_tr_b16 v[50:51], v22 offset:9216
    s_waitcnt lgkmcnt(6)
    v_mfma_f32_32x32x16_bf16 a[0:15], v[52:55], v[36:39], a[0:15]
    v_mfma_f32_32x32x16_bf16 a[16:31], v[56:59], v[36:39], a[16:31]
    v_mfma_f32_32x32x16_bf16 a[32:47], v[52:55], v[40:43], a[32:47]
    v_mfma_f32_32x32x16_bf16 a[48:63], v[56:59], v[40:43], a[48:63]
    ds_read_b128 v[36:39], v20 offset:0
    ds_read_b128 v[40:43], v20 offset:4096
    ds_read_b64_tr_b16 v[52:53], v21 offset:12288
    ds_read_b64_tr_b16 v[54:55], v21 offset:13312
    ds_read_b64_tr_b16 v[56:57], v22 offset:12288
    ds_read_b64_tr_b16 v[58:59], v22 offset:13312
    s_waitcnt lgkmcnt(6)
    v_mfma_f32_32x32x16_bf16 a[0:15], v[44:47], v[28:31], a[0:15]
    v_mfma_f32_32x32x16_bf16 a[16:31], v[48:51], v[28:31], a[16:31]
    v_mfma_f32_32x32x16_bf16 a[32:47], v[44:47], v[32:35], a[32:47]
    v_mfma_f32_32x32x16_bf16 a[48:63], v[48:51], v[32:35], a[48:63]
    s_waitcnt lgkmcnt(0)
    s_waitcnt vmcnt(8)
    s_barrier
    s_mul_i32 s44, s40, 4096
    s_add_u32 m0, s44, 65536
    s_add_u32 s43, s41, 1408
    buffer_load_dwordx4 v8, s[8:11], s43 offen lds
    s_mul_i32 s44, s40, 4096
    s_add_u32 m0, s44, 66560
    s_add_u32 s43, s41, 56704
    buffer_load_dwordx4 v9, s[8:11], s43 offen lds
    s_mul_i32 s44, s40, 4096
    s_add_u32 m0, s44, 67584
    s_add_u32 s43, s41, 112000
    buffer_load_dwordx4 v8, s[8:11], s43 offen lds
    s_mul_i32 s44, s40, 4096
    s_add_u32 m0, s44, 68608
    s_add_u32 s43, s41, 167296
    buffer_load_dwordx4 v9, s[8:11], s43 offen lds
    s_lshl_b32 s44, s40, 12
    s_add_u32 m0, s44, 81920
    s_mul_i32 s43, s26, 704
    s_add_u32 s43, s43, s42
    buffer_load_dwordx4 v10, s[12:15], s43 offen lds
    s_lshl_b32 s44, s40, 12
    s_add_u32 m0, s44, 82944
    s_mul_i32 s43, s26, 708
    s_add_u32 s43, s43, s42
    buffer_load_dwordx4 v10, s[12:15], s43 offen lds
    s_lshl_b32 s44, s40, 12
    s_add_u32 m0, s44, 83968
    s_mul_i32 s43, s26, 712
    s_add_u32 s43, s43, s42
    buffer_load_dwordx4 v10, s[12:15], s43 offen lds
    s_lshl_b32 s44, s40, 12
    s_add_u32 m0, s44, 84992
    s_mul_i32 s43, s26, 716
    s_add_u32 s43, s43, s42
    buffer_load_dwordx4 v10, s[12:15], s43 offen lds
    v_add_u32 v17, 0, v11
    v_add_u32 v18, 0, v12
    v_add_u32 v19, 0, v13
    v_add_u32 v20, 0, v14
    v_add_u32 v21, 0, v15
    v_add_u32 v22, 0, v16
    ds_read_b128 v[28:31], v17 offset:0
    ds_read_b128 v[32:35], v17 offset:4096
    ds_read_b64_tr_b16 v[44:45], v21 offset:0
    ds_read_b64_tr_b16 v[46:47], v21 offset:1024
    ds_read_b64_tr_b16 v[48:49], v22 offset:0
    ds_read_b64_tr_b16 v[50:51], v22 offset:1024
    v_mfma_f32_32x32x16_bf16 a[0:15], v[52:55], v[36:39], a[0:15]
    v_mfma_f32_32x32x16_bf16 a[16:31], v[56:59], v[36:39], a[16:31]
    v_mfma_f32_32x32x16_bf16 a[32:47], v[52:55], v[40:43], a[32:47]
    v_mfma_f32_32x32x16_bf16 a[48:63], v[56:59], v[40:43], a[48:63]
    ds_read_b128 v[36:39], v18 offset:0
    ds_read_b128 v[40:43], v18 offset:4096
    ds_read_b64_tr_b16 v[52:53], v21 offset:4096
    ds_read_b64_tr_b16 v[54:55], v21 offset:5120
    ds_read_b64_tr_b16 v[56:57], v22 offset:4096
    ds_read_b64_tr_b16 v[58:59], v22 offset:5120
    s_waitcnt lgkmcnt(6)
    v_mfma_f32_32x32x16_bf16 a[0:15], v[44:47], v[28:31], a[0:15]
    v_mfma_f32_32x32x16_bf16 a[16:31], v[48:51], v[28:31], a[16:31]
    v_mfma_f32_32x32x16_bf16 a[32:47], v[44:47], v[32:35], a[32:47]
    v_mfma_f32_32x32x16_bf16 a[48:63], v[48:51], v[32:35], a[48:63]
    ds_read_b128 v[28:31], v19 offset:0
    ds_read_b128 v[32:35], v19 offset:4096
    ds_read_b64_tr_b16 v[44:45], v21 offset:8192
    ds_read_b64_tr_b16 v[46:47], v21 offset:9216
    ds_read_b64_tr_b16 v[48:49], v22 offset:8192
    ds_read_b64_tr_b16 v[50:51], v22 offset:9216
    s_waitcnt lgkmcnt(6)
    v_mfma_f32_32x32x16_bf16 a[0:15], v[52:55], v[36:39], a[0:15]
    v_mfma_f32_32x32x16_bf16 a[16:31], v[56:59], v[36:39], a[16:31]
    v_mfma_f32_32x32x16_bf16 a[32:47], v[52:55], v[40:43], a[32:47]
    v_mfma_f32_32x32x16_bf16 a[48:63], v[56:59], v[40:43], a[48:63]
    ds_read_b128 v[36:39], v20 offset:0
    ds_read_b128 v[40:43], v20 offset:4096
    ds_read_b64_tr_b16 v[52:53], v21 offset:12288
    ds_read_b64_tr_b16 v[54:55], v21 offset:13312
    ds_read_b64_tr_b16 v[56:57], v22 offset:12288
    ds_read_b64_tr_b16 v[58:59], v22 offset:13312
    s_waitcnt lgkmcnt(6)
    v_mfma_f32_32x32x16_bf16 a[0:15], v[44:47], v[28:31], a[0:15]
    v_mfma_f32_32x32x16_bf16 a[16:31], v[48:51], v[28:31], a[16:31]
    v_mfma_f32_32x32x16_bf16 a[32:47], v[44:47], v[32:35], a[32:47]
    v_mfma_f32_32x32x16_bf16 a[48:63], v[48:51], v[32:35], a[48:63]
    s_waitcnt lgkmcnt(0)
    s_waitcnt vmcnt(8)
    s_barrier
    v_add_u32 v17, 32768, v11
    v_add_u32 v18, 32768, v12
    v_add_u32 v19, 32768, v13
    v_add_u32 v20, 32768, v14
    v_add_u32 v21, 32768, v15
    v_add_u32 v22, 32768, v16
    ds_read_b128 v[28:31], v17 offset:0
    ds_read_b128 v[32:35], v17 offset:4096
    ds_read_b64_tr_b16 v[44:45], v21 offset:0
    ds_read_b64_tr_b16 v[46:47], v21 offset:1024
    ds_read_b64_tr_b16 v[48:49], v22 offset:0
    ds_read_b64_tr_b16 v[50:51], v22 offset:1024
    v_mfma_f32_32x32x16_bf16 a[0:15], v[52:55], v[36:39], a[0:15]
    v_mfma_f32_32x32x16_bf16 a[16:31], v[56:59], v[36:39], a[16:31]
    v_mfma_f32_32x32x16_bf16 a[32:47], v[52:55], v[40:43], a[32:47]
    v_mfma_f32_32x32x16_bf16 a[48:63], v[56:59], v[40:43], a[48:63]
    ds_read_b128 v[36:39], v18 offset:0
    ds_read_b128 v[40:43], v18 offset:4096
    ds_read_b64_tr_b16 v[52:53], v21 offset:4096
    ds_read_b64_tr_b16 v[54:55], v21 offset:5120
    ds_read_b64_tr_b16 v[56:57], v22 offset:4096
    ds_read_b64_tr_b16 v[58:59], v22 offset:5120
    s_waitcnt lgkmcnt(6)
    v_mfma_f32_32x32x16_bf16 a[0:15], v[44:47], v[28:31], a[0:15]
    v_mfma_f32_32x32x16_bf16 a[16:31], v[48:51], v[28:31], a[16:31]
    v_mfma_f32_32x32x16_bf16 a[32:47], v[44:47], v[32:35], a[32:47]
    v_mfma_f32_32x32x16_bf16 a[48:63], v[48:51], v[32:35], a[48:63]
    ds_read_b128 v[28:31], v19 offset:0
    ds_read_b128 v[32:35], v19 offset:4096
    ds_read_b64_tr_b16 v[44:45], v21 offset:8192
    ds_read_b64_tr_b16 v[46:47], v21 offset:9216
    ds_read_b64_tr_b16 v[48:49], v22 offset:8192
    ds_read_b64_tr_b16 v[50:51], v22 offset:9216
    s_waitcnt lgkmcnt(6)
    v_mfma_f32_32x32x16_bf16 a[0:15], v[52:55], v[36:39], a[0:15]
    v_mfma_f32_32x32x16_bf16 a[16:31], v[56:59], v[36:39], a[16:31]
    v_mfma_f32_32x32x16_bf16 a[32:47], v[52:55], v[40:43], a[32:47]
    v_mfma_f32_32x32x16_bf16 a[48:63], v[56:59], v[40:43], a[48:63]
    ds_read_b128 v[36:39], v20 offset:0
    ds_read_b128 v[40:43], v20 offset:4096
    ds_read_b64_tr_b16 v[52:53], v21 offset:12288
    ds_read_b64_tr_b16 v[54:55], v21 offset:13312
    ds_read_b64_tr_b16 v[56:57], v22 offset:12288
    ds_read_b64_tr_b16 v[58:59], v22 offset:13312
    s_waitcnt lgkmcnt(6)
    v_mfma_f32_32x32x16_bf16 a[0:15], v[44:47], v[28:31], a[0:15]
    v_mfma_f32_32x32x16_bf16 a[16:31], v[48:51], v[28:31], a[16:31]
    v_mfma_f32_32x32x16_bf16 a[32:47], v[44:47], v[32:35], a[32:47]
    v_mfma_f32_32x32x16_bf16 a[48:63], v[48:51], v[32:35], a[48:63]
    s_waitcnt lgkmcnt(0)
    s_waitcnt vmcnt(0)
    s_barrier
    v_add_u32 v17, 65536, v11
    v_add_u32 v18, 65536, v12
    v_add_u32 v19, 65536, v13
    v_add_u32 v20, 65536, v14
    v_add_u32 v21, 65536, v15
    v_add_u32 v22, 65536, v16
    ds_read_b128 v[28:31], v17 offset:0
    ds_read_b128 v[32:35], v17 offset:4096
    ds_read_b64_tr_b16 v[44:45], v21 offset:0
    ds_read_b64_tr_b16 v[46:47], v21 offset:1024
    ds_read_b64_tr_b16 v[48:49], v22 offset:0
    ds_read_b64_tr_b16 v[50:51], v22 offset:1024
    v_mfma_f32_32x32x16_bf16 a[0:15], v[52:55], v[36:39], a[0:15]
    v_mfma_f32_32x32x16_bf16 a[16:31], v[56:59], v[36:39], a[16:31]
    v_mfma_f32_32x32x16_bf16 a[32:47], v[52:55], v[40:43], a[32:47]
    v_mfma_f32_32x32x16_bf16 a[48:63], v[56:59], v[40:43], a[48:63]
    ds_read_b128 v[36:39], v18 offset:0
    ds_read_b128 v[40:43], v18 offset:4096
    ds_read_b64_tr_b16 v[52:53], v21 offset:4096
    ds_read_b64_tr_b16 v[54:55], v21 offset:5120
    ds_read_b64_tr_b16 v[56:57], v22 offset:4096
    ds_read_b64_tr_b16 v[58:59], v22 offset:5120
    s_waitcnt lgkmcnt(6)
    v_mfma_f32_32x32x16_bf16 a[0:15], v[44:47], v[28:31], a[0:15]
    v_mfma_f32_32x32x16_bf16 a[16:31], v[48:51], v[28:31], a[16:31]
    v_mfma_f32_32x32x16_bf16 a[32:47], v[44:47], v[32:35], a[32:47]
    v_mfma_f32_32x32x16_bf16 a[48:63], v[48:51], v[32:35], a[48:63]
    ds_read_b128 v[28:31], v19 offset:0
    ds_read_b128 v[32:35], v19 offset:4096
    ds_read_b64_tr_b16 v[44:45], v21 offset:8192
    ds_read_b64_tr_b16 v[46:47], v21 offset:9216
    ds_read_b64_tr_b16 v[48:49], v22 offset:8192
    ds_read_b64_tr_b16 v[50:51], v22 offset:9216
    s_waitcnt lgkmcnt(6)
    v_mfma_f32_32x32x16_bf16 a[0:15], v[52:55], v[36:39], a[0:15]
    v_mfma_f32_32x32x16_bf16 a[16:31], v[56:59], v[36:39], a[16:31]
    v_mfma_f32_32x32x16_bf16 a[32:47], v[52:55], v[40:43], a[32:47]
    v_mfma_f32_32x32x16_bf16 a[48:63], v[56:59], v[40:43], a[48:63]
    ds_read_b128 v[36:39], v20 offset:0
    ds_read_b128 v[40:43], v20 offset:4096
    ds_read_b64_tr_b16 v[52:53], v21 offset:12288
    ds_read_b64_tr_b16 v[54:55], v21 offset:13312
    ds_read_b64_tr_b16 v[56:57], v22 offset:12288
    ds_read_b64_tr_b16 v[58:59], v22 offset:13312
    s_waitcnt lgkmcnt(6)
    v_mfma_f32_32x32x16_bf16 a[0:15], v[44:47], v[28:31], a[0:15]
    v_mfma_f32_32x32x16_bf16 a[16:31], v[48:51], v[28:31], a[16:31]
    v_mfma_f32_32x32x16_bf16 a[32:47], v[44:47], v[32:35], a[32:47]
    v_mfma_f32_32x32x16_bf16 a[48:63], v[48:51], v[32:35], a[48:63]
    s_waitcnt lgkmcnt(0)
    v_mfma_f32_32x32x16_bf16 a[0:15], v[52:55], v[36:39], a[0:15]
    v_mfma_f32_32x32x16_bf16 a[16:31], v[56:59], v[36:39], a[16:31]
    v_mfma_f32_32x32x16_bf16 a[32:47], v[52:55], v[40:43], a[32:47]
    v_mfma_f32_32x32x16_bf16 a[48:63], v[56:59], v[40:43], a[48:63]
    s_nop 15
    s_waitcnt lgkmcnt(0)
    s_barrier
    v_and_b32 v3, 63, v0
    v_and_b32 v4, 31, v3
    s_lshr_b32 s30, s40, 1
    s_mul_i32 s30, s30, 64
    v_add_u32 v4, s30, v4
    v_mul_u32_u24 v1, 528, v4
    v_lshrrev_b32 v4, 5, v3
    v_mul_u32_u24 v4, 16, v4
    v_add_u32 v1, v4, v1
    s_and_b32 s30, s40, 1
    s_mul_i32 s30, s30, 256
    v_add_u32 v1, s30, v1
    v_accvgpr_read_b32 v60, a0
    v_accvgpr_read_b32 v61, a1
    v_accvgpr_read_b32 v62, a2
    v_accvgpr_read_b32 v63, a3
    ds_write_b128 v1, v[60:63] offset:0
    v_accvgpr_read_b32 v60, a4
    v_accvgpr_read_b32 v61, a5
    v_accvgpr_read_b32 v62, a6
    v_accvgpr_read_b32 v63, a7
    ds_write_b128 v1, v[60:63] offset:32
    v_accvgpr_read_b32 v60, a8
    v_accvgpr_read_b32 v61, a9
    v_accvgpr_read_b32 v62, a10
    v_accvgpr_read_b32 v63, a11
    ds_write_b128 v1, v[60:63] offset:64
    v_accvgpr_read_b32 v60, a12
    v_accvgpr_read_b32 v61, a13
    v_accvgpr_read_b32 v62, a14
    v_accvgpr_read_b32 v63, a15
    ds_write_b128 v1, v[60:63] offset:96
    v_accvgpr_read_b32 v60, a16
    v_accvgpr_read_b32 v61, a17
    v_accvgpr_read_b32 v62, a18
    v_accvgpr_read_b32 v63, a19
    ds_write_b128 v1, v[60:63] offset:128
    v_accvgpr_read_b32 v60, a20
    v_accvgpr_read_b32 v61, a21
    v_accvgpr_read_b32 v62, a22
    v_accvgpr_read_b32 v63, a23
    ds_write_b128 v1, v[60:63] offset:160
    v_accvgpr_read_b32 v60, a24
    v_accvgpr_read_b32 v61, a25
    v_accvgpr_read_b32 v62, a26
    v_accvgpr_read_b32 v63, a27
    ds_write_b128 v1, v[60:63] offset:192
    v_accvgpr_read_b32 v60, a28
    v_accvgpr_read_b32 v61, a29
    v_accvgpr_read_b32 v62, a30
    v_accvgpr_read_b32 v63, a31
    ds_write_b128 v1, v[60:63] offset:224
    v_accvgpr_read_b32 v60, a32
    v_accvgpr_read_b32 v61, a33
    v_accvgpr_read_b32 v62, a34
    v_accvgpr_read_b32 v63, a35
    ds_write_b128 v1, v[60:63] offset:16896
    v_accvgpr_read_b32 v60, a36
    v_accvgpr_read_b32 v61, a37
    v_accvgpr_read_b32 v62, a38
    v_accvgpr_read_b32 v63, a39
    ds_write_b128 v1, v[60:63] offset:16928
    v_accvgpr_read_b32 v60, a40
    v_accvgpr_read_b32 v61, a41
    v_accvgpr_read_b32 v62, a42
    v_accvgpr_read_b32 v63, a43
    ds_write_b128 v1, v[60:63] offset:16960
    v_accvgpr_read_b32 v60, a44
    v_accvgpr_read_b32 v61, a45
    v_accvgpr_read_b32 v62, a46
    v_accvgpr_read_b32 v63, a47
    ds_write_b128 v1, v[60:63] offset:16992
    v_accvgpr_read_b32 v60, a48
    v_accvgpr_read_b32 v61, a49
    v_accvgpr_read_b32 v62, a50
    v_accvgpr_read_b32 v63, a51
    ds_write_b128 v1, v[60:63] offset:17024
    v_accvgpr_read_b32 v60, a52
    v_accvgpr_read_b32 v61, a53
    v_accvgpr_read_b32 v62, a54
    v_accvgpr_read_b32 v63, a55
    ds_write_b128 v1, v[60:63] offset:17056
    v_accvgpr_read_b32 v60, a56
    v_accvgpr_read_b32 v61, a57
    v_accvgpr_read_b32 v62, a58
    v_accvgpr_read_b32 v63, a59
    ds_write_b128 v1, v[60:63] offset:17088
    v_accvgpr_read_b32 v60, a60
    v_accvgpr_read_b32 v61, a61
    v_accvgpr_read_b32 v62, a62
    v_accvgpr_read_b32 v63, a63
    ds_write_b128 v1, v[60:63] offset:17120
    s_waitcnt lgkmcnt(0)
    s_barrier
    v_lshrrev_b32 v2, 5, v0
    v_and_b32 v3, 31, v0
    v_mul_u32_u24 v1, 528, v2
    v_lshl_add_u32 v1, v3, 4, v1
    s_lshl_b32 s30, s21, 7
    v_add_u32 v2, s30, v2
    v_mul_u32_u24 v2, 2560, v2
    v_lshl_add_u32 v2, v3, 4, v2
    s_lshl_b32 s31, s20, 9
    v_add_u32 v2, s31, v2
    s_mul_i32 s38, s37, 5242880
    ds_read_b128 v[60:63], v1 offset:0
    s_waitcnt lgkmcnt(0)
    s_add_u32 s31, s38, 0
    buffer_store_dwordx4 v[60:63], v2, s[16:19], s31 offen
    ds_read_b128 v[64:67], v1 offset:4224
    s_waitcnt lgkmcnt(0)
    s_add_u32 s31, s38, 20480
    buffer_store_dwordx4 v[64:67], v2, s[16:19], s31 offen
    ds_read_b128 v[68:71], v1 offset:8448
    s_waitcnt lgkmcnt(0)
    s_add_u32 s31, s38, 40960
    buffer_store_dwordx4 v[68:71], v2, s[16:19], s31 offen
    ds_read_b128 v[72:75], v1 offset:12672
    s_waitcnt lgkmcnt(0)
    s_add_u32 s31, s38, 61440
    buffer_store_dwordx4 v[72:75], v2, s[16:19], s31 offen
    ds_read_b128 v[60:63], v1 offset:16896
    s_waitcnt lgkmcnt(0)
    s_add_u32 s31, s38, 81920
    buffer_store_dwordx4 v[60:63], v2, s[16:19], s31 offen
    ds_read_b128 v[64:67], v1 offset:21120
    s_waitcnt lgkmcnt(0)
    s_add_u32 s31, s38, 102400
    buffer_store_dwordx4 v[64:67], v2, s[16:19], s31 offen
    ds_read_b128 v[68:71], v1 offset:25344
    s_waitcnt lgkmcnt(0)
    s_add_u32 s31, s38, 122880
    buffer_store_dwordx4 v[68:71], v2, s[16:19], s31 offen
    ds_read_b128 v[72:75], v1 offset:29568
    s_waitcnt lgkmcnt(0)
    s_add_u32 s31, s38, 143360
    buffer_store_dwordx4 v[72:75], v2, s[16:19], s31 offen
    ds_read_b128 v[60:63], v1 offset:33792
    s_waitcnt lgkmcnt(0)
    s_add_u32 s31, s38, 163840
    buffer_store_dwordx4 v[60:63], v2, s[16:19], s31 offen
    ds_read_b128 v[64:67], v1 offset:38016
    s_waitcnt lgkmcnt(0)
    s_add_u32 s31, s38, 184320
    buffer_store_dwordx4 v[64:67], v2, s[16:19], s31 offen
    ds_read_b128 v[68:71], v1 offset:42240
    s_waitcnt lgkmcnt(0)
    s_add_u32 s31, s38, 204800
    buffer_store_dwordx4 v[68:71], v2, s[16:19], s31 offen
    ds_read_b128 v[72:75], v1 offset:46464
    s_waitcnt lgkmcnt(0)
    s_add_u32 s31, s38, 225280
    buffer_store_dwordx4 v[72:75], v2, s[16:19], s31 offen
    ds_read_b128 v[60:63], v1 offset:50688
    s_waitcnt lgkmcnt(0)
    s_add_u32 s31, s38, 245760
    buffer_store_dwordx4 v[60:63], v2, s[16:19], s31 offen
    ds_read_b128 v[64:67], v1 offset:54912
    s_waitcnt lgkmcnt(0)
    s_add_u32 s31, s38, 266240
    buffer_store_dwordx4 v[64:67], v2, s[16:19], s31 offen
    ds_read_b128 v[68:71], v1 offset:59136
    s_waitcnt lgkmcnt(0)
    s_add_u32 s31, s38, 286720
    buffer_store_dwordx4 v[68:71], v2, s[16:19], s31 offen
    ds_read_b128 v[72:75], v1 offset:63360
    s_waitcnt lgkmcnt(0)
    s_add_u32 s31, s38, 307200
    buffer_store_dwordx4 v[72:75], v2, s[16:19], s31 offen
    s_branch mid_kernel_done1
mid_kernel_att2:
    s_add_u32 s8, s24, 2621440
    s_addc_u32 s9, s25, 0
    s_and_b32 s9, s9, 0xffff
    s_mov_b32 s10, 14155776
    s_mov_b32 s11, 0x00020000
    s_add_u32 s12, s24, 16777216
    s_addc_u32 s13, s25, 0
    s_and_b32 s13, s13, 0xffff
    s_mov_b32 s14, 2621440
    s_mov_b32 s15, 0x00020000
    s_and_b32 s20, s36, 31
    s_lshr_b32 s21, s36, 5
    s_lshl_b32 s21, s21, 7
    s_mul_i32 s22, s20, 40
    v_lshrrev_b32 v1, 6, v0
    s_nop 0
    v_readfirstlane_b32 s40, v1
    v_add_u32 v2, 0, v0
    s_sub_u32 s23, s21, 256
    v_add_u32 v3, s23, v2
    v_mul_lo_u32 v3, v3, s26
    v_add_u32 v3, s22, v3
    buffer_load_dwordx2 v[10:11], v3, s[8:11], 0 offen offset:1280
    buffer_load_dwordx2 v[20:21], v3, s[8:11], 0 offen offset:2560
    buffer_load_dwordx2 v[12:13], v3, s[8:11], 0 offen offset:1288
    buffer_load_dwordx2 v[22:23], v3, s[8:11], 0 offen offset:2568
    buffer_load_dwordx2 v[14:15], v3, s[8:11], 0 offen offset:1296
    buffer_load_dwordx2 v[24:25], v3, s[8:11], 0 offen offset:2576
    buffer_load_dwordx2 v[16:17], v3, s[8:11], 0 offen offset:1304
    buffer_load_dwordx2 v[26:27], v3, s[8:11], 0 offen offset:2584
    buffer_load_dwordx2 v[18:19], v3, s[8:11], 0 offen offset:1312
    buffer_load_dwordx2 v[28:29], v3, s[8:11], 0 offen offset:2592
    v_lshlrev_b32 v4, 6, v2
    v_bfe_u32 v5, v2, 2, 2
    v_mov_b32 v30, 0
    v_mov_b32 v31, 0
    v_mov_b32 v32, 0
    v_mov_b32 v33, 0
    v_xor_b32 v6, 0, v5
    v_lshl_add_u32 v34, v6, 4, v4
    v_xor_b32 v6, 1, v5
    v_lshl_add_u32 v35, v6, 4, v4
    v_xor_b32 v6, 2, v5
    v_lshl_add_u32 v36, v6, 4, v4
    v_xor_b32 v6, 3, v5
    v_lshl_add_u32 v37, v6, 4, v4
    ds_write_b64 v36, v[30:31] offset:8
    ds_write_b128 v37, v[30:33] offset:0
    ds_write_b64 v4, v[30:31] offset:24616
    ds_write_b128 v4, v[30:33] offset:24624
    s_waitcnt vmcnt(0)
    ds_write_b64 v34, v[10:11] offset:0
    ds_write_b64 v4, v[20:21] offset:24576
    ds_write_b64 v34, v[12:13] offset:8
    ds_write_b64 v4, v[22:23] offset:24584
    ds_write_b64 v35, v[14:15] offset:0
    ds_write_b64 v4, v[24:25] offset:24592
    ds_write_b64 v35, v[16:17] offset:8
    ds_write_b64 v4, v[26:27] offset:24600
    ds_write_b64 v36, v[18:19] offset:0
    ds_write_b64 v4, v[28:29] offset:24608
    v_cmp_gt_u32 vcc, 128, v0
    s_and_saveexec_b64 s[34:35], vcc
    s_cbranch_execz mid_kernel_stg4
    v_add_u32 v2, 256, v0
    s_sub_u32 s23, s21, 256
    v_add_u32 v3, s23, v2
    v_mul_lo_u32 v3, v3, s26
    v_add_u32 v3, s22, v3
    buffer_load_dwordx2 v[10:11], v3, s[8:11], 0 offen offset:1280
    buffer_load_dwordx2 v[20:21], v3, s[8:11], 0 offen offset:2560
    buffer_load_dwordx2 v[12:13], v3, s[8:11], 0 offen offset:1288
    buffer_load_dwordx2 v[22:23], v3, s[8:11], 0 offen offset:2568
    buffer_load_dwordx2 v[14:15], v3, s[8:11], 0 offen offset:1296
    buffer_load_dwordx2 v[24:25], v3, s[8:11], 0 offen offset:2576
    buffer_load_dwordx2 v[16:17], v3, s[8:11], 0 offen offset:1304
    buffer_load_dwordx2 v[26:27], v3, s[8:11], 0 offen offset:2584
    buffer_load_dwordx2 v[18:19], v3, s[8:11], 0 offen offset:1312
    buffer_load_dwordx2 v[28:29], v3, s[8:11], 0 offen offset:2592
    v_lshlrev_b32 v4, 6, v2
    v_bfe_u32 v5, v2, 2, 2
    v_mov_b32 v30, 0
    v_mov_b32 v31, 0
    v_mov_b32 v32, 0
    v_mov_b32 v33, 0
    v_xor_b32 v6, 0, v5
    v_lshl_add_u32 v34, v6, 4, v4
    v_xor_b32 v6, 1, v5
    v_lshl_add_u32 v35, v6, 4, v4
    v_xor_b32 v6, 2, v5
    v_lshl_add_u32 v36, v6, 4, v4
    v_xor_b32 v6, 3, v5
    v_lshl_add_u32 v37, v6, 4, v4
    ds_write_b64 v36, v[30:31] offset:8
    ds_write_b128 v37, v[30:33] offset:0
    ds_write_b64 v4, v[30:31] offset:24616
    ds_write_b128 v4, v[30:33] offset:24624
    s_waitcnt vmcnt(0)
    ds_write_b64 v34, v[10:11] offset:0
    ds_write_b64 v4, v[20:21] offset:24576
    ds_write_b64 v34, v[12:13] offset:8
    ds_write_b64 v4, v[22:23] offset:24584
    ds_write_b64 v35, v[14:15] offset:0
    ds_write_b64 v4, v[24:25] offset:24592
    ds_write_b64 v35, v[16:17] offset:8
    ds_write_b64 v4, v[26:27] offset:24600
    ds_write_b64 v36, v[18:19] offset:0
    ds_write_b64 v4, v[28:29] offset:24608
mid_kernel_stg4:
    s_mov_b64 exec, s[34:35]
    v_and_b32 v1, 63, v0
    v_and_b32 v2, 31, v1
    v_lshrrev_b32 v3, 5, v1
    s_lshl_b32 s23, s40, 5
    s_add_u32 s27, s23, s21
    v_add_u32 v4, s27, v2
    v_mul_lo_u32 v5, v4, s26
    v_add_u32 v5, s22, v5
    v_lshl_add_u32 v6, v3, 4, v5
    buffer_load_dwordx4 v[8:11], v6, s[8:11], 0 offen
    buffer_load_dwordx2 v[12:13], v5, s[8:11], 0 offen offset:32
    v_mov_b32 v14, 0
    v_mov_b32 v15, 0
    v_mul_u32_u24 v7, 1280, v4
    v_add_u32 v7, s22, v7
    v_lshl_add_u32 v7, v3, 3, v7
    v_bfe_u32 v16, v2, 2, 2
    v_lshl_add_u32 v17, s23, 6, 0
    v_lshl_add_u32 v17, v2, 6, v17
    v_xor_b32 v18, v3, v16
    v_lshl_add_u32 v18, v18, 4, v17
    v_add_u32 v19, 2, v3
    v_xor_b32 v19, v19, v16
    v_lshl_add_u32 v19, v19, 4, v17
    v_lshlrev_b32 v20, 2, v3
    v_bfe_u32 v21, v1, 2, 2
    v_add_u32 v20, v20, v21
    v_add_u32 v20, s23, v20
    v_lshlrev_b32 v20, 6, v20
    v_bfe_u32 v21, v1, 4, 1
    v_lshl_add_u32 v20, v21, 5, v20
    v_and_b32 v21, 3, v1
    v_lshl_add_u32 v20, v21, 3, v20
    v_add_u32 v20, 24576, v20
    v_lshlrev_b32 v21, 2, v3
    v_sub_u32 v21, v2, v21
    s_waitcnt vmcnt(0)
    v_cmp_eq_u32 vcc, 0, v3
    s_nop 0
    v_cndmask_b32 v12, 0, v12, vcc
    v_cndmask_b32 v13, 0, v13, vcc
    s_waitcnt lgkmcnt(0)
    s_barrier
    v_mov_b32 v22, 0xf149f2ca
    s_add_u32 s28, s27, 0
    s_cmp_lt_u32 s28, 256
    s_cbranch_scc1 mid_kernel_sk5
    ds_read_b128 v[24:27], v18 offset:0
    ds_read_b128 v[28:31], v19 offset:0
    s_waitcnt lgkmcnt(1)
    v_mfma_f32_32x32x16_bf16 v[64:79], v[24:27], v[8:11], 0
    s_waitcnt lgkmcnt(0)
    v_mfma_f32_32x32x16_bf16 v[64:79], v[28:31], v[12:15], v[64:79]
    s_nop 11
    v_cmp_le_i32 vcc, 0, v21
    s_nop 0
    v_cndmask_b32 v64, v64, v22, vcc
    v_cmp_le_i32 vcc, 1, v21
    s_nop 0
    v_cndmask_b32 v65, v65, v22, vcc
    v_cmp_le_i32 vcc, 2, v21
    s_nop 0
    v_cndmask_b32 v66, v66, v22, vcc
    v_cmp_le_i32 vcc, 3, v21
    s_nop 0
    v_cndmask_b32 v67, v67, v22, vcc
    v_cmp_le_i32 vcc, 8, v21
    s_nop 0
    v_cndmask_b32 v68, v68, v22, vcc
    v_cmp_le_i32 vcc, 9, v21
    s_nop 0
    v_cndmask_b32 v69, v69, v22, vcc
    v_cmp_le_i32 vcc, 10, v21
    s_nop 0
    v_cndmask_b32 v70, v70, v22, vcc
    v_cmp_le_i32 vcc, 11, v21
    s_nop 0
    v_cndmask_b32 v71, v71, v22, vcc
    v_cmp_le_i32 vcc, 16, v21
    s_nop 0
    v_cndmask_b32 v72, v72, v22, vcc
    v_cmp_le_i32 vcc, 17, v21
    s_nop 0
    v_cndmask_b32 v73, v73, v22, vcc
    v_cmp_le_i32 vcc, 18, v21
    s_nop 0
    v_cndmask_b32 v74, v74, v22, vcc
    v_cmp_le_i32 vcc, 19, v21
    s_nop 0
    v_cndmask_b32 v75, v75, v22, vcc
    v_cmp_le_i32 vcc, 24, v21
    s_nop 0
    v_cndmask_b32 v76, v76, v22, vcc
    v_cmp_le_i32 vcc, 25, v21
    s_nop 0
    v_cndmask_b32 v77, v77, v22, vcc
    v_cmp_le_i32 vcc, 26, v21
    s_nop 0
    v_cndmask_b32 v78, v78, v22, vcc
    v_cmp_le_i32 vcc, 27, v21
    s_nop 0
    v_cndmask_b32 v79, v79, v22, vcc
    s_branch mid_kernel_nx6
mid_kernel_sk5:
    v_mov_b32 v64, v22
    v_mov_b32 v65, v22
    v_mov_b32 v66, v22
    v_mov_b32 v67, v22
    v_mov_b32 v68, v22
    v_mov_b32 v69, v22
    v_mov_b32 v70, v22
    v_mov_b32 v71, v22
    v_mov_b32 v72, v22
    v_mov_b32 v73, v22
    v_mov_b32 v74, v22
    v_mov_b32 v75, v22
    v_mov_b32 v76, v22
    v_mov_b32 v77, v22
    v_mov_b32 v78, v22
    v_mov_b32 v79, v22
mid_kernel_nx6:
    s_add_u32 s28, s27, 32
    s_cmp_lt_u32 s28, 256
    s_cbranch_scc1 mid_kernel_sk7
    ds_read_b128 v[24:27], v18 offset:2048
    ds_read_b128 v[28:31], v19 offset:2048
    s_waitcnt lgkmcnt(1)
    v_mfma_f32_32x32x16_bf16 v[80:95], v[24:27], v[8:11], 0
    s_waitcnt lgkmcnt(0)
    v_mfma_f32_32x32x16_bf16 v[80:95], v[28:31], v[12:15], v[80:95]
    s_branch mid_kernel_nx8
mid_kernel_sk7:
    v_mov_b32 v80, v22
    v_mov_b32 v81, v22
    v_mov_b32 v82, v22
    v_mov_b32 v83, v22
    v_mov_b32 v84, v22
    v_mov_b32 v85, v22
    v_mov_b32 v86, v22
    v_mov_b32 v87, v22
    v_mov_b32 v88, v22
    v_mov_b32 v89, v22
    v_mov_b32 v90, v22
    v_mov_b32 v91, v22
    v_mov_b32 v92, v22
    v_mov_b32 v93, v22
    v_mov_b32 v94, v22
    v_mov_b32 v95, v22
mid_kernel_nx8:
    s_add_u32 s28, s27, 64
    s_cmp_lt_u32 s28, 256
    s_cbranch_scc1 mid_kernel_sk9
    ds_read_b128 v[24:27], v18 offset:4096
    ds_read_b128 v[28:31], v19 offset:4096
    s_waitcnt lgkmcnt(1)
    v_mfma_f32_32x32x16_bf16 v[96:111], v[24:27], v[8:11], 0
    s_waitcnt lgkmcnt(0)
    v_mfma_f32_32x32x16_bf16 v[96:111], v[28:31], v[12:15], v[96:111]
    s_branch mid_kernel_nx10
mid_kernel_sk9:
    v_mov_b32 v96, v22
    v_mov_b32 v97, v22
    v_mov_b32 v98, v22
    v_mov_b32 v99, v22
    v_mov_b32 v100, v22
    v_mov_b32 v101, v22
    v_mov_b32 v102, v22
    v_mov_b32 v103, v22
    v_mov_b32 v104, v22
    v_mov_b32 v105, v22
    v_mov_b32 v106, v22
    v_mov_b32 v107, v22
    v_mov_b32 v108, v22
    v_mov_b32 v109, v22
    v_mov_b32 v110, v22
    v_mov_b32 v111, v22
mid_kernel_nx10:
    s_add_u32 s28, s27, 96
    s_cmp_lt_u32 s28, 256
    s_cbranch_scc1 mid_kernel_sk11
    ds_read_b128 v[24:27], v18 offset:6144
    ds_read_b128 v[28:31], v19 offset:6144
    s_waitcnt lgkmcnt(1)
    v_mfma_f32_32x32x16_bf16 v[112:127], v[24:27], v[8:11], 0
    s_waitcnt lgkmcnt(0)
    v_mfma_f32_32x32x16_bf16 v[112:127], v[28:31], v[12:15], v[112:127]
    s_branch mid_kernel_nx12
mid_kernel_sk11:
    v_mov_b32 v112, v22
    v_mov_b32 v113, v22
    v_mov_b32 v114, v22
    v_mov_b32 v115, v22
    v_mov_b32 v116, v22
    v_mov_b32 v117, v22
    v_mov_b32 v118, v22
    v_mov_b32 v119, v22
    v_mov_b32 v120, v22
    v_mov_b32 v121, v22
    v_mov_b32 v122, v22
    v_mov_b32 v123, v22
    v_mov_b32 v124, v22
    v_mov_b32 v125, v22
    v_mov_b32 v126, v22
    v_mov_b32 v127, v22
mid_kernel_nx12:
    s_add_u32 s28, s27, 128
    s_cmp_lt_u32 s28, 256
    s_cbranch_scc1 mid_kernel_sk13
    ds_read_b128 v[24:27], v18 offset:8192
    ds_read_b128 v[28:31], v19 offset:8192
    s_waitcnt lgkmcnt(1)
    v_mfma_f32_32x32x16_bf16 v[128:143], v[24:27], v[8:11], 0
    s_waitcnt lgkmcnt(0)
    v_mfma_f32_32x32x16_bf16 v[128:143], v[28:31], v[12:15], v[128:143]
    s_branch mid_kernel_nx14
mid_kernel_sk13:
    v_mov_b32 v128, v22
    v_mov_b32 v129, v22
    v_mov_b32 v130, v22
    v_mov_b32 v131, v22
    v_mov_b32 v132, v22
    v_mov_b32 v133, v22
    v_mov_b32 v134, v22
    v_mov_b32 v135, v22
    v_mov_b32 v136, v22
    v_mov_b32 v137, v22
    v_mov_b32 v138, v22
    v_mov_b32 v139, v22
    v_mov_b32 v140, v22
    v_mov_b32 v141, v22
    v_mov_b32 v142, v22
    v_mov_b32 v143, v22
mid_kernel_nx14:
    s_add_u32 s28, s27, 160
    s_cmp_lt_u32 s28, 256
    s_cbranch_scc1 mid_kernel_sk15
    ds_read_b128 v[24:27], v18 offset:10240
    ds_read_b128 v[28:31], v19 offset:10240
    s_waitcnt lgkmcnt(1)
    v_mfma_f32_32x32x16_bf16 v[144:159], v[24:27], v[8:11], 0
    s_waitcnt lgkmcnt(0)
    v_mfma_f32_32x32x16_bf16 v[144:159], v[28:31], v[12:15], v[144:159]
    s_branch mid_kernel_nx16
mid_kernel_sk15:
    v_mov_b32 v144, v22
    v_mov_b32 v145, v22
    v_mov_b32 v146, v22
    v_mov_b32 v147, v22
    v_mov_b32 v148, v22
    v_mov_b32 v149, v22
    v_mov_b32 v150, v22
    v_mov_b32 v151, v22
    v_mov_b32 v152, v22
    v_mov_b32 v153, v22
    v_mov_b32 v154, v22
    v_mov_b32 v155, v22
    v_mov_b32 v156, v22
    v_mov_b32 v157, v22
    v_mov_b32 v158, v22
    v_mov_b32 v159, v22
mid_kernel_nx16:
    s_add_u32 s28, s27, 192
    s_cmp_lt_u32 s28, 256
    s_cbranch_scc1 mid_kernel_sk17
    ds_read_b128 v[24:27], v18 offset:12288
    ds_read_b128 v[28:31], v19 offset:12288
    s_waitcnt lgkmcnt(1)
    v_mfma_f32_32x32x16_bf16 v[160:175], v[24:27], v[8:11], 0
    s_waitcnt lgkmcnt(0)
    v_mfma_f32_32x32x16_bf16 v[160:175], v[28:31], v[12:15], v[160:175]
    s_branch mid_kernel_nx18
mid_kernel_sk17:
    v_mov_b32 v160, v22
    v_mov_b32 v161, v22
    v_mov_b32 v162, v22
    v_mov_b32 v163, v22
    v_mov_b32 v164, v22
    v_mov_b32 v165, v22
    v_mov_b32 v166, v22
    v_mov_b32 v167, v22
    v_mov_b32 v168, v22
    v_mov_b32 v169, v22
    v_mov_b32 v170, v22
    v_mov_b32 v171, v22
    v_mov_b32 v172, v22
    v_mov_b32 v173, v22
    v_mov_b32 v174, v22
    v_mov_b32 v175, v22
mid_kernel_nx18:
    s_add_u32 s28, s27, 224
    s_cmp_lt_u32 s28, 256
    s_cbranch_scc1 mid_kernel_sk19
    ds_read_b128 v[24:27], v18 offset:14336
    ds_read_b128 v[28:31], v19 offset:14336
    s_waitcnt lgkmcnt(1)
    v_mfma_f32_32x32x16_bf16 v[176:191], v[24:27], v[8:11], 0
    s_waitcnt lgkmcnt(0)
    v_mfma_f32_32x32x16_bf16 v[176:191], v[28:31], v[12:15], v[176:191]
    s_branch mid_kernel_nx20
mid_kernel_sk19:
    v_mov_b32 v176, v22
    v_mov_b32 v177, v22
    v_mov_b32 v178, v22
    v_mov_b32 v179, v22
    v_mov_b32 v180, v22
    v_mov_b32 v181, v22
    v_mov_b32 v182, v22
    v_mov_b32 v183, v22
    v_mov_b32 v184, v22
    v_mov_b32 v185, v22
    v_mov_b32 v186, v22
    v_mov_b32 v187, v22
    v_mov_b32 v188, v22
    v_mov_b32 v189, v22
    v_mov_b32 v190, v22
    v_mov_b32 v191, v22
mid_kernel_nx20:
    s_add_u32 s28, s27, 256
    s_cmp_lt_u32 s28, 256
    s_cbranch_scc1 mid_kernel_sk21
    ds_read_b128 v[24:27], v18 offset:16384
    ds_read_b128 v[28:31], v19 offset:16384
    s_waitcnt lgkmcnt(1)
    v_mfma_f32_32x32x16_bf16 v[192:207], v[24:27], v[8:11], 0
    s_waitcnt lgkmcnt(0)
    v_mfma_f32_32x32x16_bf16 v[192:207], v[28:31], v[12:15], v[192:207]
    s_nop 11
    v_cmp_gt_i32 vcc, 0, v21
    s_nop 0
    v_cndmask_b32 v192, v192, v22, vcc
    v_cmp_gt_i32 vcc, 1, v21
    s_nop 0
    v_cndmask_b32 v193, v193, v22, vcc
    v_cmp_gt_i32 vcc, 2, v21
    s_nop 0
    v_cndmask_b32 v194, v194, v22, vcc
    v_cmp_gt_i32 vcc, 3, v21
    s_nop 0
    v_cndmask_b32 v195, v195, v22, vcc
    v_cmp_gt_i32 vcc, 8, v21
    s_nop 0
    v_cndmask_b32 v196, v196, v22, vcc
    v_cmp_gt_i32 vcc, 9, v21
    s_nop 0
    v_cndmask_b32 v197, v197, v22, vcc
    v_cmp_gt_i32 vcc, 10, v21
    s_nop 0
    v_cndmask_b32 v198, v198, v22, vcc
    v_cmp_gt_i32 vcc, 11, v21
    s_nop 0
    v_cndmask_b32 v199, v199, v22, vcc
    v_cmp_gt_i32 vcc, 16, v21
    s_nop 0
    v_cndmask_b32 v200, v200, v22, vcc
    v_cmp_gt_i32 vcc, 17, v21
    s_nop 0
    v_cndmask_b32 v201, v201, v22, vcc
    v_cmp_gt_i32 vcc, 18, v21
    s_nop 0
    v_cndmask_b32 v202, v202, v22, vcc
    v_cmp_gt_i32 vcc, 19, v21
    s_nop 0
    v_cndmask_b32 v203, v203, v22, vcc
    v_cmp_gt_i32 vcc, 24, v21
    s_nop 0
    v_cndmask_b32 v204, v204, v22, vcc
    v_cmp_gt_i32 vcc, 25, v21
    s_nop 0
    v_cndmask_b32 v205, v205, v22, vcc
    v_cmp_gt_i32 vcc, 26, v21
    s_nop 0
    v_cndmask_b32 v206, v206, v22, vcc
    v_cmp_gt_i32 vcc, 27, v21
    s_nop 0
    v_cndmask_b32 v207, v207, v22, vcc
    s_branch mid_kernel_nx22
mid_kernel_sk21:
    v_mov_b32 v192, v22
    v_mov_b32 v193, v22
    v_mov_b32 v194, v22
    v_mov_b32 v195, v22
    v_mov_b32 v196, v22
    v_mov_b32 v197, v22
    v_mov_b32 v198, v22
    v_mov_b32 v199, v22
    v_mov_b32 v200, v22
    v_mov_b32 v201, v22
    v_mov_b32 v202, v22
    v_mov_b32 v203, v22
    v_mov_b32 v204, v22
    v_mov_b32 v205, v22
    v_mov_b32 v206, v22
    v_mov_b32 v207, v22
mid_kernel_nx22:
    s_nop 11
    v_max3_f32 v23, v64, v65, v66
    v_max3_f32 v23, v23, v67, v68
    v_max3_f32 v23, v23, v69, v70
    v_max3_f32 v23, v23, v71, v72
    v_max3_f32 v23, v23, v73, v74
    v_max3_f32 v23, v23, v75, v76
    v_max3_f32 v23, v23, v77, v78
    v_max3_f32 v23, v23, v79, v80
    v_max3_f32 v23, v23, v81, v82
    v_max3_f32 v23, v23, v83, v84
    v_max3_f32 v23, v23, v85, v86
    v_max3_f32 v23, v23, v87, v88
    v_max3_f32 v23, v23, v89, v90
    v_max3_f32 v23, v23, v91, v92
    v_max3_f32 v23, v23, v93, v94
    v_max3_f32 v23, v23, v95, v96
    v_max3_f32 v23, v23, v97, v98
    v_max3_f32 v23, v23, v99, v100
    v_max3_f32 v23, v23, v101, v102
    v_max3_f32 v23, v23, v103, v104
    v_max3_f32 v23, v23, v105, v106
    v_max3_f32 v23, v23, v107, v108
    v_max3_f32 v23, v23, v109, v110
    v_max3_f32 v23, v23, v111, v112
    v_max3_f32 v23, v23, v113, v114
    v_max3_f32 v23, v23, v115, v116
    v_max3_f32 v23, v23, v117, v118
    v_max3_f32 v23, v23, v119, v120
    v_max3_f32 v23, v23, v121, v122
    v_max3_f32 v23, v23, v123, v124
    v_max3_f32 v23, v23, v125, v126
    v_max3_f32 v23, v23, v127, v128
    v_max3_f32 v23, v23, v129, v130
    v_max3_f32 v23, v23, v131, v132
    v_max3_f32 v23, v23, v133, v134
    v_max3_f32 v23, v23, v135, v136
    v_max3_f32 v23, v23, v137, v138
    v_max3_f32 v23, v23, v139, v140
    v_max3_f32 v23, v23, v141, v142
    v_max3_f32 v23, v23, v143, v144
    v_max3_f32 v23, v23, v145, v146
    v_max3_f32 v23, v23, v147, v148
    v_max3_f32 v23, v23, v149, v150
    v_max3_f32 v23, v23, v151, v152
    v_max3_f32 v23, v23, v153, v154
    v_max3_f32 v23, v23, v155, v156
    v_max3_f32 v23, v23, v157, v158
    v_max3_f32 v23, v23, v159, v160
    v_max3_f32 v23, v23, v161, v162
    v_max3_f32 v23, v23, v163, v164
    v_max3_f32 v23, v23, v165, v166
    v_max3_f32 v23, v23, v167, v168
    v_max3_f32 v23, v23, v169, v170
    v_max3_f32 v23, v23, v171, v172
    v_max3_f32 v23, v23, v173, v174
    v_max3_f32 v23, v23, v175, v176
    v_max3_f32 v23, v23, v177, v178
    v_max3_f32 v23, v23, v179, v180
    v_max3_f32 v23, v23, v181, v182
    v_max3_f32 v23, v23, v183, v184
    v_max3_f32 v23, v23, v185, v186
    v_max3_f32 v23, v23, v187, v188
    v_max3_f32 v23, v23, v189, v190
    v_max3_f32 v23, v23, v191, v192
    v_max3_f32 v23, v23, v193, v194
    v_max3_f32 v23, v23, v195, v196
    v_max3_f32 v23, v23, v197, v198
    v_max3_f32 v23, v23, v199, v200
    v_max3_f32 v23, v23, v201, v202
    v_max3_f32 v23, v23, v203, v204
    v_max3_f32 v23, v23, v205, v206
    v_max_f32 v23, v23, v207
    v_mov_b32 v24, v23
    s_nop 1
    v_permlane32_swap_b32 v23, v24
    s_nop 0
    v_max_f32 v23, v23, v24
    s_mov_b32 s29, 0.3225964182229561
    v_mul_f32 v23, s29, v23
    v_mov_b32 v25, 0
    v_mov_b32 v26, 0
    v_fma_f32 v64, v64, s29, -v23
    v_fma_f32 v65, v65, s29, -v23
    v_fma_f32 v66, v66, s29, -v23
    v_fma_f32 v67, v67, s29, -v23
    v_fma_f32 v68, v68, s29, -v23
    v_fma_f32 v69, v69, s29, -v23
    v_fma_f32 v70, v70, s29, -v23
    v_fma_f32 v71, v71, s29, -v23
    v_fma_f32 v72, v72, s29, -v23
    v_fma_f32 v73, v73, s29, -v23
    v_fma_f32 v74, v74, s29, -v23
    v_fma_f32 v75, v75, s29, -v23
    v_fma_f32 v76, v76, s29, -v23
    v_fma_f32 v77, v77, s29, -v23
    v_fma_f32 v78, v78, s29, -v23
    v_fma_f32 v79, v79, s29, -v23
    v_fma_f32 v80, v80, s29, -v23
    v_fma_f32 v81, v81, s29, -v23
    v_fma_f32 v82, v82, s29, -v23
    v_fma_f32 v83, v83, s29, -v23
    v_fma_f32 v84, v84, s29, -v23
    v_fma_f32 v85, v85, s29, -v23
    v_fma_f32 v86, v86, s29, -v23
    v_fma_f32 v87, v87, s29, -v23
    v_fma_f32 v88, v88, s29, -v23
    v_fma_f32 v89, v89, s29, -v23
    v_fma_f32 v90, v90, s29, -v23
    v_fma_f32 v91, v91, s29, -v23
    v_fma_f32 v92, v92, s29, -v23
    v_fma_f32 v93, v93, s29, -v23
    v_fma_f32 v94, v94, s29, -v23
    v_fma_f32 v95, v95, s29, -v23
    v_fma_f32 v96, v96, s29, -v23
    v_fma_f32 v97, v97, s29, -v23
    v_fma_f32 v98, v98, s29, -v23
    v_fma_f32 v99, v99, s29, -v23
    v_fma_f32 v100, v100, s29, -v23
    v_fma_f32 v101, v101, s29, -v23
    v_fma_f32 v102, v102, s29, -v23
    v_fma_f32 v103, v103, s29, -v23
    v_fma_f32 v104, v104, s29, -v23
    v_fma_f32 v105, v105, s29, -v23
    v_fma_f32 v106, v106, s29, -v23
    v_fma_f32 v107, v107, s29, -v23
    v_fma_f32 v108, v108, s29, -v23
    v_fma_f32 v109, v109, s29, -v23
    v_fma_f32 v110, v110, s29, -v23
    v_fma_f32 v111, v111, s29, -v23
    v_fma_f32 v112, v112, s29, -v23
    v_fma_f32 v113, v113, s29, -v23
    v_fma_f32 v114, v114, s29, -v23
    v_fma_f32 v115, v115, s29, -v23
    v_fma_f32 v116, v116, s29, -v23
    v_fma_f32 v117, v117, s29, -v23
    v_fma_f32 v118, v118, s29, -v23
    v_fma_f32 v119, v119, s29, -v23
    v_fma_f32 v120, v120, s29, -v23
    v_fma_f32 v121, v121, s29, -v23
    v_fma_f32 v122, v122, s29, -v23
    v_fma_f32 v123, v123, s29, -v23
    v_fma_f32 v124, v124, s29, -v23
    v_fma_f32 v125, v125, s29, -v23
    v_fma_f32 v126, v126, s29, -v23
    v_fma_f32 v127, v127, s29, -v23
    v_fma_f32 v128, v128, s29, -v23
    v_fma_f32 v129, v129, s29, -v23
    v_fma_f32 v130, v130, s29, -v23
    v_fma_f32 v131, v131, s29, -v23
    v_fma_f32 v132, v132, s29, -v23
    v_fma_f32 v133, v133, s29, -v23
    v_fma_f32 v134, v134, s29, -v23
    v_fma_f32 v135, v135, s29, -v23
    v_fma_f32 v136, v136, s29, -v23
    v_fma_f32 v137, v137, s29, -v23
    v_fma_f32 v138, v138, s29, -v23
    v_fma_f32 v139, v139, s29, -v23
    v_fma_f32 v140, v140, s29, -v23
    v_fma_f32 v141, v141, s29, -v23
    v_fma_f32 v142, v142, s29, -v23
    v_fma_f32 v143, v143, s29, -v23
    v_fma_f32 v144, v144, s29, -v23
    v_fma_f32 v145, v145, s29, -v23
    v_fma_f32 v146, v146, s29, -v23
    v_fma_f32 v147, v147, s29, -v23
    v_fma_f32 v148, v148, s29, -v23
    v_fma_f32 v149, v149, s29, -v23
    v_fma_f32 v150, v150, s29, -v23
    v_fma_f32 v151, v151, s29, -v23
    v_fma_f32 v152, v152, s29, -v23
    v_fma_f32 v153, v153, s29, -v23
    v_fma_f32 v154, v154, s29, -v23
    v_fma_f32 v155, v155, s29, -v23
    v_fma_f32 v156, v156, s29, -v23
    v_fma_f32 v157, v157, s29, -v23
    v_fma_f32 v158, v158, s29, -v23
    v_fma_f32 v159, v159, s29, -v23
    v_fma_f32 v160, v160, s29, -v23
    v_fma_f32 v161, v161, s29, -v23
    v_fma_f32 v162, v162, s29, -v23
    v_fma_f32 v163, v163, s29, -v23
    v_fma_f32 v164, v164, s29, -v23
    v_fma_f32 v165, v165, s29, -v23
    v_fma_f32 v166, v166, s29, -v23
    v_fma_f32 v167, v167, s29, -v23
    v_fma_f32 v168, v168, s29, -v23
    v_fma_f32 v169, v169, s29, -v23
    v_fma_f32 v170, v170, s29, -v23
    v_fma_f32 v171, v171, s29, -v23
    v_fma_f32 v172, v172, s29, -v23
    v_fma_f32 v173, v173, s29, -v23
    v_fma_f32 v174, v174, s29, -v23
    v_fma_f32 v175, v175, s29, -v23
    v_fma_f32 v176, v176, s29, -v23
    v_fma_f32 v177, v177, s29, -v23
    v_fma_f32 v178, v178, s29, -v23
    v_fma_f32 v179, v179, s29, -v23
    v_fma_f32 v180, v180, s29, -v23
    v_fma_f32 v181, v181, s29, -v23
    v_fma_f32 v182, v182, s29, -v23
    v_fma_f32 v183, v183, s29, -v23
    v_fma_f32 v184, v184, s29, -v23
    v_fma_f32 v185, v185, s29, -v23
    v_fma_f32 v186, v186, s29, -v23
    v_fma_f32 v187, v187, s29, -v23
    v_fma_f32 v188, v188, s29, -v23
    v_fma_f32 v189, v189, s29, -v23
    v_fma_f32 v190, v190, s29, -v23
    v_fma_f32 v191, v191, s29, -v23
    v_fma_f32 v192, v192, s29, -v23
    v_fma_f32 v193, v193, s29, -v23
    v_fma_f32 v194, v194, s29, -v23
    v_fma_f32 v195, v195, s29, -v23
    v_fma_f32 v196, v196, s29, -v23
    v_fma_f32 v197, v197, s29, -v23
    v_fma_f32 v198, v198, s29, -v23
    v_fma_f32 v199, v199, s29, -v23
    v_fma_f32 v200, v200, s29, -v23
    v_fma_f32 v201, v201, s29, -v23
    v_fma_f32 v202, v202, s29, -v23
    v_fma_f32 v203, v203, s29, -v23
    v_fma_f32 v204, v204, s29, -v23
    v_fma_f32 v205, v205, s29, -v23
    v_fma_f32 v206, v206, s29, -v23
    v_fma_f32 v207, v207, s29, -v23
    v_exp_f32 v64, v64
    v_exp_f32 v65, v65
    v_exp_f32 v66, v66
    v_exp_f32 v67, v67
    v_exp_f32 v68, v68
    v_exp_f32 v69, v69
    v_exp_f32 v70, v70
    v_exp_f32 v71, v71
    v_exp_f32 v72, v72
    v_exp_f32 v73, v73
    v_exp_f32 v74, v74
    v_exp_f32 v75, v75
    v_exp_f32 v76, v76
    v_exp_f32 v77, v77
    v_exp_f32 v78, v78
    v_exp_f32 v79, v79
    v_exp_f32 v80, v80
    v_exp_f32 v81, v81
    v_exp_f32 v82, v82
    v_exp_f32 v83, v83
    v_exp_f32 v84, v84
    v_exp_f32 v85, v85
    v_exp_f32 v86, v86
    v_exp_f32 v87, v87
    v_exp_f32 v88, v88
    v_exp_f32 v89, v89
    v_exp_f32 v90, v90
    v_exp_f32 v91, v91
    v_exp_f32 v92, v92
    v_exp_f32 v93, v93
    v_exp_f32 v94, v94
    v_exp_f32 v95, v95
    v_exp_f32 v96, v96
    v_exp_f32 v97, v97
    v_exp_f32 v98, v98
    v_exp_f32 v99, v99
    v_exp_f32 v100, v100
    v_exp_f32 v101, v101
    v_exp_f32 v102, v102
    v_exp_f32 v103, v103
    v_exp_f32 v104, v104
    v_exp_f32 v105, v105
    v_exp_f32 v106, v106
    v_exp_f32 v107, v107
    v_exp_f32 v108, v108
    v_exp_f32 v109, v109
    v_exp_f32 v110, v110
    v_exp_f32 v111, v111
    v_exp_f32 v112, v112
    v_exp_f32 v113, v113
    v_exp_f32 v114, v114
    v_exp_f32 v115, v115
    v_exp_f32 v116, v116
    v_exp_f32 v117, v117
    v_exp_f32 v118, v118
    v_exp_f32 v119, v119
    v_exp_f32 v120, v120
    v_exp_f32 v121, v121
    v_exp_f32 v122, v122
    v_exp_f32 v123, v123
    v_exp_f32 v124, v124
    v_exp_f32 v125, v125
    v_exp_f32 v126, v126
    v_exp_f32 v127, v127
    v_exp_f32 v128, v128
    v_exp_f32 v129, v129
    v_exp_f32 v130, v130
    v_exp_f32 v131, v131
    v_exp_f32 v132, v132
    v_exp_f32 v133, v133
    v_exp_f32 v134, v134
    v_exp_f32 v135, v135
    v_exp_f32 v136, v136
    v_exp_f32 v137, v137
    v_exp_f32 v138, v138
    v_exp_f32 v139, v139
    v_exp_f32 v140, v140
    v_exp_f32 v141, v141
    v_exp_f32 v142, v142
    v_exp_f32 v143, v143
    v_exp_f32 v144, v144
    v_exp_f32 v145, v145
    v_exp_f32 v146, v146
    v_exp_f32 v147, v147
    v_exp_f32 v148, v148
    v_exp_f32 v149, v149
    v_exp_f32 v150, v150
    v_exp_f32 v151, v151
    v_exp_f32 v152, v152
    v_exp_f32 v153, v153
    v_exp_f32 v154, v154
    v_exp_f32 v155, v155
    v_exp_f32 v156, v156
    v_exp_f32 v157, v157
    v_exp_f32 v158, v158
    v_exp_f32 v159, v159
    v_exp_f32 v160, v160
    v_exp_f32 v161, v161
    v_exp_f32 v162, v162
    v_exp_f32 v163, v163
    v_exp_f32 v164, v164
    v_exp_f32 v165, v165
    v_exp_f32 v166, v166
    v_exp_f32 v167, v167
    v_exp_f32 v168, v168
    v_exp_f32 v169, v169
    v_exp_f32 v170, v170
    v_exp_f32 v171, v171
    v_exp_f32 v172, v172
    v_exp_f32 v173, v173
    v_exp_f32 v174, v174
    v_exp_f32 v175, v175
    v_exp_f32 v176, v176
    v_exp_f32 v177, v177
    v_exp_f32 v178, v178
    v_exp_f32 v179, v179
    v_exp_f32 v180, v180
    v_exp_f32 v181, v181
    v_exp_f32 v182, v182
    v_exp_f32 v183, v183
    v_exp_f32 v184, v184
    v_exp_f32 v185, v185
    v_exp_f32 v186, v186
    v_exp_f32 v187, v187
    v_exp_f32 v188, v188
    v_exp_f32 v189, v189
    v_exp_f32 v190, v190
    v_exp_f32 v191, v191
    v_exp_f32 v192, v192
    v_exp_f32 v193, v193
    v_exp_f32 v194, v194
    v_exp_f32 v195, v195
    v_exp_f32 v196, v196
    v_exp_f32 v197, v197
    v_exp_f32 v198, v198
    v_exp_f32 v199, v199
    v_exp_f32 v200, v200
    v_exp_f32 v201, v201
    v_exp_f32 v202, v202
    v_exp_f32 v203, v203
    v_exp_f32 v204, v204
    v_exp_f32 v205, v205
    v_exp_f32 v206, v206
    v_exp_f32 v207, v207
    s_nop 0
    v_add_f32 v25, v25, v64
    v_add_f32 v26, v26, v65
    v_cvt_pk_bf16_f32 v64, v64, v65
    v_add_f32 v25, v25, v66
    v_add_f32 v26, v26, v67
    v_cvt_pk_bf16_f32 v65, v66, v67
    v_add_f32 v25, v25, v68
    v_add_f32 v26, v26, v69
    v_cvt_pk_bf16_f32 v66, v68, v69
    v_add_f32 v25, v25, v70
    v_add_f32 v26, v26, v71
    v_cvt_pk_bf16_f32 v67, v70, v71
    v_add_f32 v25, v25, v72
    v_add_f32 v26, v26, v73
    v_cvt_pk_bf16_f32 v68, v72, v73
    v_add_f32 v25, v25, v74
    v_add_f32 v26, v26, v75
    v_cvt_pk_bf16_f32 v69, v74, v75
    v_add_f32 v25, v25, v76
    v_add_f32 v26, v26, v77
    v_cvt_pk_bf16_f32 v70, v76, v77
    v_add_f32 v25, v25, v78
    v_add_f32 v26, v26, v79
    v_cvt_pk_bf16_f32 v71, v78, v79
    v_add_f32 v25, v25, v80
    v_add_f32 v26, v26, v81
    v_cvt_pk_bf16_f32 v72, v80, v81
    v_add_f32 v25, v25, v82
    v_add_f32 v26, v26, v83
    v_cvt_pk_bf16_f32 v73, v82, v83
    v_add_f32 v25, v25, v84
    v_add_f32 v26, v26, v85
    v_cvt_pk_bf16_f32 v74, v84, v85
    v_add_f32 v25, v25, v86
    v_add_f32 v26, v26, v87
    v_cvt_pk_bf16_f32 v75, v86, v87
    v_add_f32 v25, v25, v88
    v_add_f32 v26, v26, v89
    v_cvt_pk_bf16_f32 v76, v88, v89
    v_add_f32 v25, v25, v90
    v_add_f32 v26, v26, v91
    v_cvt_pk_bf16_f32 v77, v90, v91
    v_add_f32 v25, v25, v92
    v_add_f32 v26, v26, v93
    v_cvt_pk_bf16_f32 v78, v92, v93
    v_add_f32 v25, v25, v94
    v_add_f32 v26, v26, v95
    v_cvt_pk_bf16_f32 v79, v94, v95
    v_add_f32 v25, v25, v96
    v_add_f32 v26, v26, v97
    v_cvt_pk_bf16_f32 v80, v96, v97
    v_add_f32 v25, v25, v98
    v_add_f32 v26, v26, v99
    v_cvt_pk_bf16_f32 v81, v98, v99
    v_add_f32 v25, v25, v100
    v_add_f32 v26, v26, v101
    v_cvt_pk_bf16_f32 v82, v100, v101
    v_add_f32 v25, v25, v102
    v_add_f32 v26, v26, v103
    v_cvt_pk_bf16_f32 v83, v102, v103
    v_add_f32 v25, v25, v104
    v_add_f32 v26, v26, v105
    v_cvt_pk_bf16_f32 v84, v104, v105
    v_add_f32 v25, v25, v106
    v_add_f32 v26, v26, v107
    v_cvt_pk_bf16_f32 v85, v106, v107
    v_add_f32 v25, v25, v108
    v_add_f32 v26, v26, v109
    v_cvt_pk_bf16_f32 v86, v108, v109
    v_add_f32 v25, v25, v110
    v_add_f32 v26, v26, v111
    v_cvt_pk_bf16_f32 v87, v110, v111
    v_add_f32 v25, v25, v112
    v_add_f32 v26, v26, v113
    v_cvt_pk_bf16_f32 v88, v112, v113
    v_add_f32 v25, v25, v114
    v_add_f32 v26, v26, v115
    v_cvt_pk_bf16_f32 v89, v114, v115
    v_add_f32 v25, v25, v116
    v_add_f32 v26, v26, v117
    v_cvt_pk_bf16_f32 v90, v116, v117
    v_add_f32 v25, v25, v118
    v_add_f32 v26, v26, v119
    v_cvt_pk_bf16_f32 v91, v118, v119
    v_add_f32 v25, v25, v120
    v_add_f32 v26, v26, v121
    v_cvt_pk_bf16_f32 v92, v120, v121
    v_add_f32 v25, v25, v122
    v_add_f32 v26, v26, v123
    v_cvt_pk_bf16_f32 v93, v122, v123
    v_add_f32 v25, v25, v124
    v_add_f32 v26, v26, v125
    v_cvt_pk_bf16_f32 v94, v124, v125
    v_add_f32 v25, v25, v126
    v_add_f32 v26, v26, v127
    v_cvt_pk_bf16_f32 v95, v126, v127
    v_add_f32 v25, v25, v128
    v_add_f32 v26, v26, v129
    v_cvt_pk_bf16_f32 v96, v128, v129
    v_add_f32 v25, v25, v130
    v_add_f32 v26, v26, v131
    v_cvt_pk_bf16_f32 v97, v130, v131
    v_add_f32 v25, v25, v132
    v_add_f32 v26, v26, v133
    v_cvt_pk_bf16_f32 v98, v132, v133
    v_add_f32 v25, v25, v134
    v_add_f32 v26, v26, v135
    v_cvt_pk_bf16_f32 v99, v134, v135
    v_add_f32 v25, v25, v136
    v_add_f32 v26, v26, v137
    v_cvt_pk_bf16_f32 v100, v136, v137
    v_add_f32 v25, v25, v138
    v_add_f32 v26, v26, v139
    v_cvt_pk_bf16_f32 v101, v138, v139
    v_add_f32 v25, v25, v140
    v_add_f32 v26, v26, v141
    v_cvt_pk_bf16_f32 v102, v140, v141
    v_add_f32 v25, v25, v142
    v_add_f32 v26, v26, v143
    v_cvt_pk_bf16_f32 v103, v142, v143
    v_add_f32 v25, v25, v144
    v_add_f32 v26, v26, v145
    v_cvt_pk_bf16_f32 v104, v144, v145
    v_add_f32 v25, v25, v146
    v_add_f32 v26, v26, v147
    v_cvt_pk_bf16_f32 v105, v146, v147
    v_add_f32 v25, v25, v148
    v_add_f32 v26, v26, v149
    v_cvt_pk_bf16_f32 v106, v148, v149
    v_add_f32 v25, v25, v150
    v_add_f32 v26, v26, v151
    v_cvt_pk_bf16_f32 v107, v150, v151
    v_add_f32 v25, v25, v152
    v_add_f32 v26, v26, v153
    v_cvt_pk_bf16_f32 v108, v152, v153
    v_add_f32 v25, v25, v154
    v_add_f32 v26, v26, v155
    v_cvt_pk_bf16_f32 v109, v154, v155
    v_add_f32 v25, v25, v156
    v_add_f32 v26, v26, v157
    v_cvt_pk_bf16_f32 v110, v156, v157
    v_add_f32 v25, v25, v158
    v_add_f32 v26, v26, v159
    v_cvt_pk_bf16_f32 v111, v158, v159
    v_add_f32 v25, v25, v160
    v_add_f32 v26, v26, v161
    v_cvt_pk_bf16_f32 v112, v160, v161
    v_add_f32 v25, v25, v162
    v_add_f32 v26, v26, v163
    v_cvt_pk_bf16_f32 v113, v162, v163
    v_add_f32 v25, v25, v164
    v_add_f32 v26, v26, v165
    v_cvt_pk_bf16_f32 v114, v164, v165
    v_add_f32 v25, v25, v166
    v_add_f32 v26, v26, v167
    v_cvt_pk_bf16_f32 v115, v166, v167
    v_add_f32 v25, v25, v168
    v_add_f32 v26, v26, v169
    v_cvt_pk_bf16_f32 v116, v168, v169
    v_add_f32 v25, v25, v170
    v_add_f32 v26, v26, v171
    v_cvt_pk_bf16_f32 v117, v170, v171
    v_add_f32 v25, v25, v172
    v_add_f32 v26, v26, v173
    v_cvt_pk_bf16_f32 v118, v172, v173
    v_add_f32 v25, v25, v174
    v_add_f32 v26, v26, v175
    v_cvt_pk_bf16_f32 v119, v174, v175
    v_add_f32 v25, v25, v176
    v_add_f32 v26, v26, v177
    v_cvt_pk_bf16_f32 v120, v176, v177
    v_add_f32 v25, v25, v178
    v_add_f32 v26, v26, v179
    v_cvt_pk_bf16_f32 v121, v178, v179
    v_add_f32 v25, v25, v180
    v_add_f32 v26, v26, v181
    v_cvt_pk_bf16_f32 v122, v180, v181
    v_add_f32 v25, v25, v182
    v_add_f32 v26, v26, v183
    v_cvt_pk_bf16_f32 v123, v182, v183
    v_add_f32 v25, v25, v184
    v_add_f32 v26, v26, v185
    v_cvt_pk_bf16_f32 v124, v184, v185
    v_add_f32 v25, v25, v186
    v_add_f32 v26, v26, v187
    v_cvt_pk_bf16_f32 v125, v186, v187
    v_add_f32 v25, v25, v188
    v_add_f32 v26, v26, v189
    v_cvt_pk_bf16_f32 v126, v188, v189
    v_add_f32 v25, v25, v190
    v_add_f32 v26, v26, v191
    v_cvt_pk_bf16_f32 v127, v190, v191
    v_add_f32 v25, v25, v192
    v_add_f32 v26, v26, v193
    v_cvt_pk_bf16_f32 v128, v192, v193
    v_add_f32 v25, v25, v194
    v_add_f32 v26, v26, v195
    v_cvt_pk_bf16_f32 v129, v194, v195
    v_add_f32 v25, v25, v196
    v_add_f32 v26, v26, v197
    v_cvt_pk_bf16_f32 v130, v196, v197
    v_add_f32 v25, v25, v198
    v_add_f32 v26, v26, v199
    v_cvt_pk_bf16_f32 v131, v198, v199
    v_add_f32 v25, v25, v200
    v_add_f32 v26, v26, v201
    v_cvt_pk_bf16_f32 v132, v200, v201
    v_add_f32 v25, v25, v202
    v_add_f32 v26, v26, v203
    v_cvt_pk_bf16_f32 v133, v202, v203
    v_add_f32 v25, v25, v204
    v_add_f32 v26, v26, v205
    v_cvt_pk_bf16_f32 v134, v204, v205
    v_add_f32 v25, v25, v206
    v_add_f32 v26, v26, v207
    v_cvt_pk_bf16_f32 v135, v206, v207
    v_add_f32 v25, v25, v26
    v_mov_b32 v26, v25
    s_nop 1
    v_permlane32_swap_b32 v25, v26
    s_nop 0
    v_add_f32 v25, v25, v26
    v_rcp_f32 v56, v25
    ds_read_b64_tr_b16 v[24:25], v20 offset:0
    ds_read_b64_tr_b16 v[26:27], v20 offset:512
    ds_read_b64_tr_b16 v[28:29], v20 offset:1024
    ds_read_b64_tr_b16 v[30:31], v20 offset:1536
    ds_read_b64_tr_b16 v[32:33], v20 offset:2048
    ds_read_b64_tr_b16 v[34:35], v20 offset:2560
    ds_read_b64_tr_b16 v[36:37], v20 offset:3072
    ds_read_b64_tr_b16 v[38:39], v20 offset:3584
    s_waitcnt lgkmcnt(6)
    v_mfma_f32_32x32x16_bf16 v[40:55], v[24:27], v[64:67], 0
    ds_read_b64_tr_b16 v[24:25], v20 offset:4096
    ds_read_b64_tr_b16 v[26:27], v20 offset:4608
    s_waitcnt lgkmcnt(6)
    v_mfma_f32_32x32x16_bf16 v[40:55], v[28:31], v[68:71], v[40:55]
    ds_read_b64_tr_b16 v[28:29], v20 offset:5120
    ds_read_b64_tr_b16 v[30:31], v20 offset:5632
    s_waitcnt lgkmcnt(6)
    v_mfma_f32_32x32x16_bf16 v[40:55], v[32:35], v[72:75], v[40:55]
    ds_read_b64_tr_b16 v[32:33], v20 offset:6144
    ds_read_b64_tr_b16 v[34:35], v20 offset:6656
    s_waitcnt lgkmcnt(6)
    v_mfma_f32_32x32x16_bf16 v[40:55], v[36:39], v[76:79], v[40:55]
    ds_read_b64_tr_b16 v[36:37], v20 offset:7168
    ds_read_b64_tr_b16 v[38:39], v20 offset:7680
    s_waitcnt lgkmcnt(6)
    v_mfma_f32_32x32x16_bf16 v[40:55], v[24:27], v[80:83], v[40:55]
    ds_read_b64_tr_b16 v[24:25], v20 offset:8192
    ds_read_b64_tr_b16 v[26:27], v20 offset:8704
    s_waitcnt lgkmcnt(6)
    v_mfma_f32_32x32x16_bf16 v[40:55], v[28:31], v[84:87], v[40:55]
    ds_read_b64_tr_b16 v[28:29], v20 offset:9216
    ds_read_b64_tr_b16 v[30:31], v20 offset:9728
    s_waitcnt lgkmcnt(6)
    v_mfma_f32_32x32x16_bf16 v[40:55], v[32:35], v[88:91], v[40:55]
    ds_read_b64_tr_b16 v[32:33], v20 offset:10240
    ds_read_b64_tr_b16 v[34:35], v20 offset:10752
    s_waitcnt lgkmcnt(6)
    v_mfma_f32_32x32x16_bf16 v[40:55], v[36:39], v[92:95], v[40:55]
    ds_read_b64_tr_b16 v[36:37], v20 offset:11264
    ds_read_b64_tr_b16 v[38:39], v20 offset:11776
    s_waitcnt lgkmcnt(6)
    v_mfma_f32_32x32x16_bf16 v[40:55], v[24:27], v[96:99], v[40:55]
    ds_read_b64_tr_b16 v[24:25], v20 offset:12288
    ds_read_b64_tr_b16 v[26:27], v20 offset:12800
    s_waitcnt lgkmcnt(6)
    v_mfma_f32_32x32x16_bf16 v[40:55], v[28:31], v[100:103], v[40:55]
    ds_read_b64_tr_b16 v[28:29], v20 offset:13312
    ds_read_b64_tr_b16 v[30:31], v20 offset:13824
    s_waitcnt lgkmcnt(6)
    v_mfma_f32_32x32x16_bf16 v[40:55], v[32:35], v[104:107], v[40:55]
    ds_read_b64_tr_b16 v[32:33], v20 offset:14336
    ds_read_b64_tr_b16 v[34:35], v20 offset:14848
    s_waitcnt lgkmcnt(6)
    v_mfma_f32_32x32x16_bf16 v[40:55], v[36:39], v[108:111], v[40:55]
    ds_read_b64_tr_b16 v[36:37], v20 offset:15360
    ds_read_b64_tr_b16 v[38:39], v20 offset:15872
    s_waitcnt lgkmcnt(6)
    v_mfma_f32_32x32x16_bf16 v[40:55], v[24:27], v[112:115], v[40:55]
    ds_read_b64_tr_b16 v[24:25], v20 offset:16384
    ds_read_b64_tr_b16 v[26:27], v20 offset:16896
    s_waitcnt lgkmcnt(6)
    v_mfma_f32_32x32x16_bf16 v[40:55], v[28:31], v[116:119], v[40:55]
    ds_read_b64_tr_b16 v[28:29], v20 offset:17408
    ds_read_b64_tr_b16 v[30:31], v20 offset:17920
    s_waitcnt lgkmcnt(6)
    v_mfma_f32_32x32x16_bf16 v[40:55], v[32:35], v[120:123], v[40:55]
    s_waitcnt lgkmcnt(4)
    v_mfma_f32_32x32x16_bf16 v[40:55], v[36:39], v[124:127], v[40:55]
    s_waitcnt lgkmcnt(2)
    v_mfma_f32_32x32x16_bf16 v[40:55], v[24:27], v[128:131], v[40:55]
    s_waitcnt lgkmcnt(0)
    v_mfma_f32_32x32x16_bf16 v[40:55], v[28:31], v[132:135], v[40:55]
    s_nop 11
    v_mul_f32 v40, v40, v56
    v_mul_f32 v41, v41, v56
    v_mul_f32 v42, v42, v56
    v_mul_f32 v43, v43, v56
    v_mul_f32 v44, v44, v56
    v_mul_f32 v45, v45, v56
    v_mul_f32 v46, v46, v56
    v_mul_f32 v47, v47, v56
    v_mul_f32 v48, v48, v56
    v_mul_f32 v49, v49, v56
    v_mul_f32 v50, v50, v56
    v_mul_f32 v51, v51, v56
    v_cvt_pk_bf16_f32 v28, v40, v41
    v_cvt_pk_bf16_f32 v29, v42, v43
    v_cvt_pk_bf16_f32 v30, v44, v45
    v_cvt_pk_bf16_f32 v31, v46, v47
    v_cvt_pk_bf16_f32 v32, v48, v49
    v_cvt_pk_bf16_f32 v33, v50, v51
    buffer_store_dwordx2 v[28:29], v7, s[12:15], 0 offen
    buffer_store_dwordx2 v[30:31], v7, s[12:15], 0 offen offset:16
    v_cmp_eq_u32 vcc, 0, v3
    s_and_saveexec_b64 s[34:35], vcc
    buffer_store_dwordx2 v[32:33], v7, s[12:15], 0 offen offset:32
    s_mov_b64 exec, s[34:35]
mid_kernel_done1:
    s_endpgm
.globl recurrent_scan__sliding_block__dense_activation_relu__prompt_kernel
.p2align 8
.type recurrent_scan__sliding_block__dense_activation_relu__prompt_kernel,@function
recurrent_scan__sliding_block__dense_activation_relu__prompt_kernel:
    s_cmp_ge_u32 s2, 80
    s_cbranch_scc1 recurrent_scan__sliding_block__dense_activation_relu__prompt_kernel_done1
    s_load_dwordx2 s[4:5], s[0:1], 16
    s_load_dwordx2 s[6:7], s[0:1], 0
    s_load_dwordx2 s[22:23], s[0:1], 48
    s_load_dwordx2 s[24:25], s[0:1], 64
    s_mul_hi_u32 s21, s2, 0x33333334
    s_mul_i32 s20, s21, 5
    s_sub_u32 s20, s2, s20
    s_waitcnt lgkmcnt(0)
    s_add_u32 s8, s24, 16777216
    s_addc_u32 s9, s25, 0
    s_and_b32 s9, s9, 0xffff
    s_mov_b32 s10, 2621440
    s_mov_b32 s11, 0x00020000
    s_add_u32 s16, s24, 20971520
    s_addc_u32 s17, s25, 0
    s_and_b32 s17, s17, 0xffff
    s_mov_b32 s18, 10485760
    s_mov_b32 s19, 0x00020000
    s_mov_b32 s12, s4
    s_and_b32 s13, s5, 0xffff
    s_mov_b32 s14, 819200
    s_mov_b32 s15, 0x00020000
    s_mov_b32 s48, s6
    s_and_b32 s49, s7, 0xffff
    s_mov_b32 s50, 2621440
    s_mov_b32 s51, 0x00020000
    s_mov_b32 s52, s22
    s_and_b32 s53, s23, 0xffff
    s_mov_b32 s54, 2621440
    s_mov_b32 s55, 0x00020000
    s_mov_b32 s26, 1280
    s_mul_i32 s28, s21, 163840
    s_lshl_b32 s27, s20, 8
    v_lshrrev_b32 v23, 6, v0
    s_nop 0
    v_readfirstlane_b32 s40, v23
    v_and_b32 v24, 63, v0
    v_lshrrev_b32 v25, 3, v24
    v_mul_u32_u24 v8, 1280, v25
    v_lshrrev_b32 v25, 4, v24
    v_and_b32 v9, 7, v24
    v_xor_b32 v25, v25, v9
    v_xor_b32 v9, 4, v25
    v_lshl_add_u32 v9, v9, 4, v8
    v_lshl_add_u32 v8, v25, 4, v8
    v_lshrrev_b32 v25, 4, v24
    v_mul_lo_u32 v10, v25, s26
    v_lshlrev_b32 v25, 2, v25
    v_and_b32 v11, 15, v24
    v_xor_b32 v25, v25, v11
    v_lshl_add_u32 v10, v25, 4, v10
    s_mul_i32 s41, s40, 40960
    s_add_u32 s41, s41, s28
    s_lshl_b32 s43, s40, 4
    s_mul_i32 s42, s43, s26
    s_add_u32 s42, s42, s27
    s_lshr_b32 s43, s40, 1
    s_mul_i32 s43, s43, 8192
    v_and_b32 v25, 31, v24
    v_lshl_add_u32 v23, v25, 7, s43
    v_bfe_u32 v25, v24, 1, 3
    v_lshrrev_b32 v17, 5, v24
    v_add_u32 v18, 0, v17
    v_xor_b32 v18, v18, v25
    v_lshl_add_u32 v11, v18, 4, v23
    v_add_u32 v18, 2, v17
    v_xor_b32 v18, v18, v25
    v_lshl_add_u32 v12, v18, 4, v23
    v_add_u32 v18, 4, v17
    v_xor_b32 v18, v18, v25
    v_lshl_add_u32 v13, v18, 4, v23
    v_add_u32 v18, 6, v17
    v_xor_b32 v18, v18, v25
    v_lshl_add_u32 v14, v18, 4, v23
    v_lshrrev_b32 v23, 5, v24
    v_lshlrev_b32 v23, 3, v23
    v_bfe_u32 v25, v24, 2, 2
    v_add_u32 v23, v23, v25
    v_lshlrev_b32 v23, 8, v23
    v_bfe_u32 v18, v24, 4, 1
    v_lshl_add_u32 v23, v18, 5, v23
    v_and_b32 v18, 3, v24
    v_lshl_add_u32 v23, v18, 3, v23
    v_add_u32 v23, 16384, v23
    s_and_b32 s43, s40, 1
    s_lshl_b32 s43, s43, 1
    s_add_u32 s44, s43, 0
    v_xor_b32 v18, s44, v25
    v_lshl_add_u32 v15, v18, 6, v23
    s_add_u32 s44, s43, 1
    v_xor_b32 v18, s44, v25
    v_lshl_add_u32 v16, v18, 6, v23
    s_mul_i32 s44, s40, 4096
    s_add_u32 m0, s44, 0
    s_add_u32 s43, s41, 0
    buffer_load_dwordx4 v8, s[8:11], s43 offen lds
    s_mul_i32 s44, s40, 4096
    s_add_u32 m0, s44, 1024
    s_add_u32 s43, s41, 10240
    buffer_load_dwordx4 v9, s[8:11], s43 offen lds
    s_mul_i32 s44, s40, 4096
    s_add_u32 m0, s44, 2048
    s_add_u32 s43, s41, 20480
    buffer_load_dwordx4 v8, s[8:11], s43 offen lds
    s_mul_i32 s44, s40, 4096
    s_add_u32 m0, s44, 3072
    s_add_u32 s43, s41, 30720
    buffer_load_dwordx4 v9, s[8:11], s43 offen lds
    s_lshl_b32 s44, s40, 12
    s_add_u32 m0, s44, 16384
    s_mul_i32 s43, s26, 0
    s_add_u32 s43, s43, s42
    buffer_load_dwordx4 v10, s[12:15], s43 offen lds
    s_lshl_b32 s44, s40, 12
    s_add_u32 m0, s44, 17408
    s_mul_i32 s43, s26, 4
    s_add_u32 s43, s43, s42
    buffer_load_dwordx4 v10, s[12:15], s43 offen lds
    s_lshl_b32 s44, s40, 12
    s_add_u32 m0, s44, 18432
    s_mul_i32 s43, s26, 8
    s_add_u32 s43, s43, s42
    buffer_load_dwordx4 v10, s[12:15], s43 offen lds
    s_lshl_b32 s44, s40, 12
    s_add_u32 m0, s44, 19456
    s_mul_i32 s43, s26, 12
    s_add_u32 s43, s43, s42
    buffer_load_dwordx4 v10, s[12:15], s43 offen lds
    s_mul_i32 s44, s40, 4096
    s_add_u32 m0, s44, 32768
    s_add_u32 s43, s41, 128
    buffer_load_dwordx4 v8, s[8:11], s43 offen lds
    s_mul_i32 s44, s40, 4096
    s_add_u32 m0, s44, 33792
    s_add_u32 s43, s41, 10368
    buffer_load_dwordx4 v9, s[8:11], s43 offen lds
    s_mul_i32 s44, s40, 4096
    s_add_u32 m0, s44, 34816
    s_add_u32 s43, s41, 20608
    buffer_load_dwordx4 v8, s[8:11], s43 offen lds
    s_mul_i32 s44, s40, 4096
    s_add_u32 m0, s44, 35840
    s_add_u32 s43, s41, 30848
    buffer_load_dwordx4 v9, s[8:11], s43 offen lds
    s_lshl_b32 s44, s40, 12
    s_add_u32 m0, s44, 49152
    s_mul_i32 s43, s26, 64
    s_add_u32 s43, s43, s42
    buffer_load_dwordx4 v10, s[12:15], s43 offen lds
    s_lshl_b32 s44, s40, 12
    s_add_u32 m0, s44, 50176
    s_mul_i32 s43, s26, 68
    s_add_u32 s43, s43, s42
    buffer_load_dwordx4 v10, s[12:15], s43 offen lds
    s_lshl_b32 s44, s40, 12
    s_add_u32 m0, s44, 51200
    s_mul_i32 s43, s26, 72
    s_add_u32 s43, s43, s42
    buffer_load_dwordx4 v10, s[12:15], s43 offen lds
    s_lshl_b32 s44, s40, 12
    s_add_u32 m0, s44, 52224
    s_mul_i32 s43, s26, 76
    s_add_u32 s43, s43, s42
    buffer_load_dwordx4 v10, s[12:15], s43 offen lds
    s_mul_i32 s44, s40, 4096
    s_add_u32 m0, s44, 65536
    s_add_u32 s43, s41, 256
    buffer_load_dwordx4 v8, s[8:11], s43 offen lds
    s_mul_i32 s44, s40, 4096
    s_add_u32 m0, s44, 66560
    s_add_u32 s43, s41, 10496
    buffer_load_dwordx4 v9, s[8:11], s43 offen lds
    s_mul_i32 s44, s40, 4096
    s_add_u32 m0, s44, 67584
    s_add_u32 s43, s41, 20736
    buffer_load_dwordx4 v8, s[8:11], s43 offen lds
    s_mul_i32 s44, s40, 4096
    s_add_u32 m0, s44, 68608
    s_add_u32 s43, s41, 30976
    buffer_load_dwordx4 v9, s[8:11], s43 offen lds
    s_lshl_b32 s44, s40, 12
    s_add_u32 m0, s44, 81920
    s_mul_i32 s43, s26, 128
    s_add_u32 s43, s43, s42
    buffer_load_dwordx4 v10, s[12:15], s43 offen lds
    s_lshl_b32 s44, s40, 12
    s_add_u32 m0, s44, 82944
    s_mul_i32 s43, s26, 132
    s_add_u32 s43, s43, s42
    buffer_load_dwordx4 v10, s[12:15], s43 offen lds
    s_lshl_b32 s44, s40, 12
    s_add_u32 m0, s44, 83968
    s_mul_i32 s43, s26, 136
    s_add_u32 s43, s43, s42
    buffer_load_dwordx4 v10, s[12:15], s43 offen lds
    s_lshl_b32 s44, s40, 12
    s_add_u32 m0, s44, 84992
    s_mul_i32 s43, s26, 140
    s_add_u32 s43, s43, s42
    buffer_load_dwordx4 v10, s[12:15], s43 offen lds
    s_waitcnt vmcnt(16)
    s_barrier
    v_add_u32 v17, 0, v11
    v_add_u32 v18, 0, v12
    v_add_u32 v19, 0, v13
    v_add_u32 v20, 0, v14
    v_add_u32 v21, 0, v15
    v_add_u32 v22, 0, v16
    ds_read_b128 v[28:31], v17 offset:0
    ds_read_b128 v[32:35], v17 offset:4096
    ds_read_b64_tr_b16 v[44:45], v21 offset:0
    ds_read_b64_tr_b16 v[46:47], v21 offset:1024
    ds_read_b64_tr_b16 v[48:49], v22 offset:0
    ds_read_b64_tr_b16 v[50:51], v22 offset:1024
    ds_read_b128 v[36:39], v18 offset:0
    ds_read_b128 v[40:43], v18 offset:4096
    ds_read_b64_tr_b16 v[52:53], v21 offset:4096
    ds_read_b64_tr_b16 v[54:55], v21 offset:5120
    ds_read_b64_tr_b16 v[56:57], v22 offset:4096
    ds_read_b64_tr_b16 v[58:59], v22 offset:5120
    s_waitcnt lgkmcnt(6)
    v_mfma_f32_32x32x16_bf16 a[0:15], v[44:47], v[28:31], 0
    v_mfma_f32_32x32x16_bf16 a[16:31], v[48:51], v[28:31], 0
    v_mfma_f32_32x32x16_bf16 a[32:47], v[44:47], v[32:35], 0
    v_mfma_f32_32x32x16_bf16 a[48:63], v[48:51], v[32:35], 0
    ds_read_b128 v[28:31], v19 offset:0
    ds_read_b128 v[32:35], v19 offset:4096
    ds_read_b64_tr_b16 v[44:45], v21 offset:8192
    ds_read_b64_tr_b16 v[46:47], v21 offset:9216
    ds_read_b64_tr_b16 v[48:49], v22 offset:8192
    ds_read_b64_tr_b16 v[50:51], v22 offset:9216
    s_waitcnt lgkmcnt(6)
    v_mfma_f32_32x32x16_bf16 a[0:15], v[52:55], v[36:39], a[0:15]
    v_mfma_f32_32x32x16_bf16 a[16:31], v[56:59], v[36:39], a[16:31]
    v_mfma_f32_32x32x16_bf16 a[32:47], v[52:55], v[40:43], a[32:47]
    v_mfma_f32_32x32x16_bf16 a[48:63], v[56:59], v[40:43], a[48:63]
    ds_read_b128 v[36:39], v20 offset:0
    ds_read_b128 v[40:43], v20 offset:4096
    ds_read_b64_tr_b16 v[52:53], v21 offset:12288
    ds_read_b64_tr_b16 v[54:55], v21 offset:13312
    ds_read_b64_tr_b16 v[56:57], v22 offset:12288
    ds_read_b64_tr_b16 v[58:59], v22 offset:13312
    s_waitcnt lgkmcnt(6)
    v_mfma_f32_32x32x16_bf16 a[0:15], v[44:47], v[28:31], a[0:15]
    v_mfma_f32_32x32x16_bf16 a[16:31], v[48:51], v[28:31], a[16:31]
    v_mfma_f32_32x32x16_bf16 a[32:47], v[44:47], v[32:35], a[32:47]
    v_mfma_f32_32x32x16_bf16 a[48:63], v[48:51], v[32:35], a[48:63]
    s_waitcnt lgkmcnt(0)
    s_waitcnt vmcnt(8)
    s_barrier
    s_mul_i32 s44, s40, 4096
    s_add_u32 m0, s44, 0
    s_add_u32 s43, s41, 384
    buffer_load_dwordx4 v8, s[8:11], s43 offen lds
    s_mul_i32 s44, s40, 4096
    s_add_u32 m0, s44, 1024
    s_add_u32 s43, s41, 10624
    buffer_load_dwordx4 v9, s[8:11], s43 offen lds
    s_mul_i32 s44, s40, 4096
    s_add_u32 m0, s44, 2048
    s_add_u32 s43, s41, 20864
    buffer_load_dwordx4 v8, s[8:11], s43 offen lds
    s_mul_i32 s44, s40, 4096
    s_add_u32 m0, s44, 3072
    s_add_u32 s43, s41, 31104
    buffer_load_dwordx4 v9, s[8:11], s43 offen lds
    s_lshl_b32 s44, s40, 12
    s_add_u32 m0, s44, 16384
    s_mul_i32 s43, s26, 192
    s_add_u32 s43, s43, s42
    buffer_load_dwordx4 v10, s[12:15], s43 offen lds
    s_lshl_b32 s44, s40, 12
    s_add_u32 m0, s44, 17408
    s_mul_i32 s43, s26, 196
    s_add_u32 s43, s43, s42
    buffer_load_dwordx4 v10, s[12:15], s43 offen lds
    s_lshl_b32 s44, s40, 12
    s_add_u32 m0, s44, 18432
    s_mul_i32 s43, s26, 200
    s_add_u32 s43, s43, s42
    buffer_load_dwordx4 v10, s[12:15], s43 offen lds
    s_lshl_b32 s44, s40, 12
    s_add_u32 m0, s44, 19456
    s_mul_i32 s43, s26, 204
    s_add_u32 s43, s43, s42
    buffer_load_dwordx4 v10, s[12:15], s43 offen lds
    v_add_u32 v17, 32768, v11
    v_add_u32 v18, 32768, v12
    v_add_u32 v19, 32768, v13
    v_add_u32 v20, 32768, v14
    v_add_u32 v21, 32768, v15
    v_add_u32 v22, 32768, v16
    ds_read_b128 v[28:31], v17 offset:0
    ds_read_b128 v[32:35], v17 offset:4096
    ds_read_b64_tr_b16 v[44:45], v21 offset:0
    ds_read_b64_tr_b16 v[46:47], v21 offset:1024
    ds_read_b64_tr_b16 v[48:49], v22 offset:0
    ds_read_b64_tr_b16 v[50:51], v22 offset:1024
    v_mfma_f32_32x32x16_bf16 a[0:15], v[52:55], v[36:39], a[0:15]
    v_mfma_f32_32x32x16_bf16 a[16:31], v[56:59], v[36:39], a[16:31]
    v_mfma_f32_32x32x16_bf16 a[32:47], v[52:55], v[40:43], a[32:47]
    v_mfma_f32_32x32x16_bf16 a[48:63], v[56:59], v[40:43], a[48:63]
    ds_read_b128 v[36:39], v18 offset:0
    ds_read_b128 v[40:43], v18 offset:4096
    ds_read_b64_tr_b16 v[52:53], v21 offset:4096
    ds_read_b64_tr_b16 v[54:55], v21 offset:5120
    ds_read_b64_tr_b16 v[56:57], v22 offset:4096
    ds_read_b64_tr_b16 v[58:59], v22 offset:5120
    s_waitcnt lgkmcnt(6)
    v_mfma_f32_32x32x16_bf16 a[0:15], v[44:47], v[28:31], a[0:15]
    v_mfma_f32_32x32x16_bf16 a[16:31], v[48:51], v[28:31], a[16:31]
    v_mfma_f32_32x32x16_bf16 a[32:47], v[44:47], v[32:35], a[32:47]
    v_mfma_f32_32x32x16_bf16 a[48:63], v[48:51], v[32:35], a[48:63]
    ds_read_b128 v[28:31], v19 offset:0
    ds_read_b128 v[32:35], v19 offset:4096
    ds_read_b64_tr_b16 v[44:45], v21 offset:8192
    ds_read_b64_tr_b16 v[46:47], v21 offset:9216
    ds_read_b64_tr_b16 v[48:49], v22 offset:8192
    ds_read_b64_tr_b16 v[50:51], v22 offset:9216
    s_waitcnt lgkmcnt(6)
    v_mfma_f32_32x32x16_bf16 a[0:15], v[52:55], v[36:39], a[0:15]
    v_mfma_f32_32x32x16_bf16 a[16:31], v[56:59], v[36:39], a[16:31]
    v_mfma_f32_32x32x16_bf16 a[32:47], v[52:55], v[40:43], a[32:47]
    v_mfma_f32_32x32x16_bf16 a[48:63], v[56:59], v[40:43], a[48:63]
    ds_read_b128 v[36:39], v20 offset:0
    ds_read_b128 v[40:43], v20 offset:4096
    ds_read_b64_tr_b16 v[52:53], v21 offset:12288
    ds_read_b64_tr_b16 v[54:55], v21 offset:13312
    ds_read_b64_tr_b16 v[56:57], v22 offset:12288
    ds_read_b64_tr_b16 v[58:59], v22 offset:13312
    s_waitcnt lgkmcnt(6)
    v_mfma_f32_32x32x16_bf16 a[0:15], v[44:47], v[28:31], a[0:15]
    v_mfma_f32_32x32x16_bf16 a[16:31], v[48:51], v[28:31], a[16:31]
    v_mfma_f32_32x32x16_bf16 a[32:47], v[44:47], v[32:35], a[32:47]
    v_mfma_f32_32x32x16_bf16 a[48:63], v[48:51], v[32:35], a[48:63]
    s_waitcnt lgkmcnt(0)
    s_waitcnt vmcnt(8)
    s_barrier
    s_mul_i32 s44, s40, 4096
    s_add_u32 m0, s44, 32768
    s_add_u32 s43, s41, 512
    buffer_load_dwordx4 v8, s[8:11], s43 offen lds
    s_mul_i32 s44, s40, 4096
    s_add_u32 m0, s44, 33792
    s_add_u32 s43, s41, 10752
    buffer_load_dwordx4 v9, s[8:11], s43 offen lds
    s_mul_i32 s44, s40, 4096
    s_add_u32 m0, s44, 34816
    s_add_u32 s43, s41, 20992
    buffer_load_dwordx4 v8, s[8:11], s43 offen lds
    s_mul_i32 s44, s40, 4096
    s_add_u32 m0, s44, 35840
    s_add_u32 s43, s41, 31232
    buffer_load_dwordx4 v9, s[8:11], s43 offen lds
    s_lshl_b32 s44, s40, 12
    s_add_u32 m0, s44, 49152
    s_mul_i32 s43, s26, 256
    s_add_u32 s43, s43, s42
    buffer_load_dwordx4 v10, s[12:15], s43 offen lds
    s_lshl_b32 s44, s40, 12
    s_add_u32 m0, s44, 50176
    s_mul_i32 s43, s26, 260
    s_add_u32 s43, s43, s42
    buffer_load_dwordx4 v10, s[12:15], s43 offen lds
    s_lshl_b32 s44, s40, 12
    s_add_u32 m0, s44, 51200
    s_mul_i32 s43, s26, 264
    s_add_u32 s43, s43, s42
    buffer_load_dwordx4 v10, s[12:15], s43 offen lds
    s_lshl_b32 s44, s40, 12
    s_add_u32 m0, s44, 52224
    s_mul_i32 s43, s26, 268
    s_add_u32 s43, s43, s42
    buffer_load_dwordx4 v10, s[12:15], s43 offen lds
    v_add_u32 v17, 65536, v11
    v_add_u32 v18, 65536, v12
    v_add_u32 v19, 65536, v13
    v_add_u32 v20, 65536, v14
    v_add_u32 v21, 65536, v15
    v_add_u32 v22, 65536, v16
    ds_read_b128 v[28:31], v17 offset:0
    ds_read_b128 v[32:35], v17 offset:4096
    ds_read_b64_tr_b16 v[44:45], v21 offset:0
    ds_read_b64_tr_b16 v[46:47], v21 offset:1024
    ds_read_b64_tr_b16 v[48:49], v22 offset:0
    ds_read_b64_tr_b16 v[50:51], v22 offset:1024
    v_mfma_f32_32x32x16_bf16 a[0:15], v[52:55], v[36:39], a[0:15]
    v_mfma_f32_32x32x16_bf16 a[16:31], v[56:59], v[36:39], a[16:31]
    v_mfma_f32_32x32x16_bf16 a[32:47], v[52:55], v[40:43], a[32:47]
    v_mfma_f32_32x32x16_bf16 a[48:63], v[56:59], v[40:43], a[48:63]
    ds_read_b128 v[36:39], v18 offset:0
    ds_read_b128 v[40:43], v18 offset:4096
    ds_read_b64_tr_b16 v[52:53], v21 offset:4096
    ds_read_b64_tr_b16 v[54:55], v21 offset:5120
    ds_read_b64_tr_b16 v[56:57], v22 offset:4096
    ds_read_b64_tr_b16 v[58:59], v22 offset:5120
    s_waitcnt lgkmcnt(6)
    v_mfma_f32_32x32x16_bf16 a[0:15], v[44:47], v[28:31], a[0:15]
    v_mfma_f32_32x32x16_bf16 a[16:31], v[48:51], v[28:31], a[16:31]
    v_mfma_f32_32x32x16_bf16 a[32:47], v[44:47], v[32:35], a[32:47]
    v_mfma_f32_32x32x16_bf16 a[48:63], v[48:51], v[32:35], a[48:63]
    ds_read_b128 v[28:31], v19 offset:0
    ds_read_b128 v[32:35], v19 offset:4096
    ds_read_b64_tr_b16 v[44:45], v21 offset:8192
    ds_read_b64_tr_b16 v[46:47], v21 offset:9216
    ds_read_b64_tr_b16 v[48:49], v22 offset:8192
    ds_read_b64_tr_b16 v[50:51], v22 offset:9216
    s_waitcnt lgkmcnt(6)
    v_mfma_f32_32x32x16_bf16 a[0:15], v[52:55], v[36:39], a[0:15]
    v_mfma_f32_32x32x16_bf16 a[16:31], v[56:59], v[36:39], a[16:31]
    v_mfma_f32_32x32x16_bf16 a[32:47], v[52:55], v[40:43], a[32:47]
    v_mfma_f32_32x32x16_bf16 a[48:63], v[56:59], v[40:43], a[48:63]
    ds_read_b128 v[36:39], v20 offset:0
    ds_read_b128 v[40:43], v20 offset:4096
    ds_read_b64_tr_b16 v[52:53], v21 offset:12288
    ds_read_b64_tr_b16 v[54:55], v21 offset:13312
    ds_read_b64_tr_b16 v[56:57], v22 offset:12288
    ds_read_b64_tr_b16 v[58:59], v22 offset:13312
    s_waitcnt lgkmcnt(6)
    v_mfma_f32_32x32x16_bf16 a[0:15], v[44:47], v[28:31], a[0:15]
    v_mfma_f32_32x32x16_bf16 a[16:31], v[48:51], v[28:31], a[16:31]
    v_mfma_f32_32x32x16_bf16 a[32:47], v[44:47], v[32:35], a[32:47]
    v_mfma_f32_32x32x16_bf16 a[48:63], v[48:51], v[32:35], a[48:63]
    s_waitcnt lgkmcnt(0)
    s_waitcnt vmcnt(8)
    s_barrier
    s_mul_i32 s44, s40, 4096
    s_add_u32 m0, s44, 65536
    s_add_u32 s43, s41, 640
    buffer_load_dwordx4 v8, s[8:11], s43 offen lds
    s_mul_i32 s44, s40, 4096
    s_add_u32 m0, s44, 66560
    s_add_u32 s43, s41, 10880
    buffer_load_dwordx4 v9, s[8:11], s43 offen lds
    s_mul_i32 s44, s40, 4096
    s_add_u32 m0, s44, 67584
    s_add_u32 s43, s41, 21120
    buffer_load_dwordx4 v8, s[8:11], s43 offen lds
    s_mul_i32 s44, s40, 4096
    s_add_u32 m0, s44, 68608
    s_add_u32 s43, s41, 31360
    buffer_load_dwordx4 v9, s[8:11], s43 offen lds
    s_lshl_b32 s44, s40, 12
    s_add_u32 m0, s44, 81920
    s_mul_i32 s43, s26, 320
    s_add_u32 s43, s43, s42
    buffer_load_dwordx4 v10, s[12:15], s43 offen lds
    s_lshl_b32 s44, s40, 12
    s_add_u32 m0, s44, 82944
    s_mul_i32 s43, s26, 324
    s_add_u32 s43, s43, s42
    buffer_load_dwordx4 v10, s[12:15], s43 offen lds
    s_lshl_b32 s44, s40, 12
    s_add_u32 m0, s44, 83968
    s_mul_i32 s43, s26, 328
    s_add_u32 s43, s43, s42
    buffer_load_dwordx4 v10, s[12:15], s43 offen lds
    s_lshl_b32 s44, s40, 12
    s_add_u32 m0, s44, 84992
    s_mul_i32 s43, s26, 332
    s_add_u32 s43, s43, s42
    buffer_load_dwordx4 v10, s[12:15], s43 offen lds
    v_add_u32 v17, 0, v11
    v_add_u32 v18, 0, v12
    v_add_u32 v19, 0, v13
    v_add_u32 v20, 0, v14
    v_add_u32 v21, 0, v15
    v_add_u32 v22, 0, v16
    ds_read_b128 v[28:31], v17 offset:0
    ds_read_b128 v[32:35], v17 offset:4096
    ds_read_b64_tr_b16 v[44:45], v21 offset:0
    ds_read_b64_tr_b16 v[46:47], v21 offset:1024
    ds_read_b64_tr_b16 v[48:49], v22 offset:0
    ds_read_b64_tr_b16 v[50:51], v22 offset:1024
    v_mfma_f32_32x32x16_bf16 a[0:15], v[52:55], v[36:39], a[0:15]
    v_mfma_f32_32x32x16_bf16 a[16:31], v[56:59], v[36:39], a[16:31]
    v_mfma_f32_32x32x16_bf16 a[32:47], v[52:55], v[40:43], a[32:47]
    v_mfma_f32_32x32x16_bf16 a[48:63], v[56:59], v[40:43], a[48:63]
    ds_read_b128 v[36:39], v18 offset:0
    ds_read_b128 v[40:43], v18 offset:4096
    ds_read_b64_tr_b16 v[52:53], v21 offset:4096
    ds_read_b64_tr_b16 v[54:55], v21 offset:5120
    ds_read_b64_tr_b16 v[56:57], v22 offset:4096
    ds_read_b64_tr_b16 v[58:59], v22 offset:5120
    s_waitcnt lgkmcnt(6)
    v_mfma_f32_32x32x16_bf16 a[0:15], v[44:47], v[28:31], a[0:15]
    v_mfma_f32_32x32x16_bf16 a[16:31], v[48:51], v[28:31], a[16:31]
    v_mfma_f32_32x32x16_bf16 a[32:47], v[44:47], v[32:35], a[32:47]
    v_mfma_f32_32x32x16_bf16 a[48:63], v[48:51], v[32:35], a[48:63]
    ds_read_b128 v[28:31], v19 offset:0
    ds_read_b128 v[32:35], v19 offset:4096
    ds_read_b64_tr_b16 v[44:45], v21 offset:8192
    ds_read_b64_tr_b16 v[46:47], v21 offset:9216
    ds_read_b64_tr_b16 v[48:49], v22 offset:8192
    ds_read_b64_tr_b16 v[50:51], v22 offset:9216
    s_waitcnt lgkmcnt(6)
    v_mfma_f32_32x32x16_bf16 a[0:15], v[52:55], v[36:39], a[0:15]
    v_mfma_f32_32x32x16_bf16 a[16:31], v[56:59], v[36:39], a[16:31]
    v_mfma_f32_32x32x16_bf16 a[32:47], v[52:55], v[40:43], a[32:47]
    v_mfma_f32_32x32x16_bf16 a[48:63], v[56:59], v[40:43], a[48:63]
    ds_read_b128 v[36:39], v20 offset:0
    ds_read_b128 v[40:43], v20 offset:4096
    ds_read_b64_tr_b16 v[52:53], v21 offset:12288
    ds_read_b64_tr_b16 v[54:55], v21 offset:13312
    ds_read_b64_tr_b16 v[56:57], v22 offset:12288
    ds_read_b64_tr_b16 v[58:59], v22 offset:13312
    s_waitcnt lgkmcnt(6)
    v_mfma_f32_32x32x16_bf16 a[0:15], v[44:47], v[28:31], a[0:15]
    v_mfma_f32_32x32x16_bf16 a[16:31], v[48:51], v[28:31], a[16:31]
    v_mfma_f32_32x32x16_bf16 a[32:47], v[44:47], v[32:35], a[32:47]
    v_mfma_f32_32x32x16_bf16 a[48:63], v[48:51], v[32:35], a[48:63]
    s_waitcnt lgkmcnt(0)
    s_waitcnt vmcnt(8)
    s_barrier
    s_mul_i32 s44, s40, 4096
    s_add_u32 m0, s44, 0
    s_add_u32 s43, s41, 768
    buffer_load_dwordx4 v8, s[8:11], s43 offen lds
    s_mul_i32 s44, s40, 4096
    s_add_u32 m0, s44, 1024
    s_add_u32 s43, s41, 11008
    buffer_load_dwordx4 v9, s[8:11], s43 offen lds
    s_mul_i32 s44, s40, 4096
    s_add_u32 m0, s44, 2048
    s_add_u32 s43, s41, 21248
    buffer_load_dwordx4 v8, s[8:11], s43 offen lds
    s_mul_i32 s44, s40, 4096
    s_add_u32 m0, s44, 3072
    s_add_u32 s43, s41, 31488
    buffer_load_dwordx4 v9, s[8:11], s43 offen lds
    s_lshl_b32 s44, s40, 12
    s_add_u32 m0, s44, 16384
    s_mul_i32 s43, s26, 384
    s_add_u32 s43, s43, s42
    buffer_load_dwordx4 v10, s[12:15], s43 offen lds
    s_lshl_b32 s44, s40, 12
    s_add_u32 m0, s44, 17408
    s_mul_i32 s43, s26, 388
    s_add_u32 s43, s43, s42
    buffer_load_dwordx4 v10, s[12:15], s43 offen lds
    s_lshl_b32 s44, s40, 12
    s_add_u32 m0, s44, 18432
    s_mul_i32 s43, s26, 392
    s_add_u32 s43, s43, s42
    buffer_load_dwordx4 v10, s[12:15], s43 offen lds
    s_lshl_b32 s44, s40, 12
    s_add_u32 m0, s44, 19456
    s_mul_i32 s43, s26, 396
    s_add_u32 s43, s43, s42
    buffer_load_dwordx4 v10, s[12:15], s43 offen lds
    v_add_u32 v17, 32768, v11
    v_add_u32 v18, 32768, v12
    v_add_u32 v19, 32768, v13
    v_add_u32 v20, 32768, v14
    v_add_u32 v21, 32768, v15
    v_add_u32 v22, 32768, v16
    ds_read_b128 v[28:31], v17 offset:0
    ds_read_b128 v[32:35], v17 offset:4096
    ds_read_b64_tr_b16 v[44:45], v21 offset:0
    ds_read_b64_tr_b16 v[46:47], v21 offset:1024
    ds_read_b64_tr_b16 v[48:49], v22 offset:0
    ds_read_b64_tr_b16 v[50:51], v22 offset:1024
    v_mfma_f32_32x32x16_bf16 a[0:15], v[52:55], v[36:39], a[0:15]
    v_mfma_f32_32x32x16_bf16 a[16:31], v[56:59], v[36:39], a[16:31]
    v_mfma_f32_32x32x16_bf16 a[32:47], v[52:55], v[40:43], a[32:47]
    v_mfma_f32_32x32x16_bf16 a[48:63], v[56:59], v[40:43], a[48:63]
    ds_read_b128 v[36:39], v18 offset:0
    ds_read_b128 v[40:43], v18 offset:4096
    ds_read_b64_tr_b16 v[52:53], v21 offset:4096
    ds_read_b64_tr_b16 v[54:55], v21 offset:5120
    ds_read_b64_tr_b16 v[56:57], v22 offset:4096
    ds_read_b64_tr_b16 v[58:59], v22 offset:5120
    s_waitcnt lgkmcnt(6)
    v_mfma_f32_32x32x16_bf16 a[0:15], v[44:47], v[28:31], a[0:15]
    v_mfma_f32_32x32x16_bf16 a[16:31], v[48:51], v[28:31], a[16:31]
    v_mfma_f32_32x32x16_bf16 a[32:47], v[44:47], v[32:35], a[32:47]
    v_mfma_f32_32x32x16_bf16 a[48:63], v[48:51], v[32:35], a[48:63]
    ds_read_b128 v[28:31], v19 offset:0
    ds_read_b128 v[32:35], v19 offset:4096
    ds_read_b64_tr_b16 v[44:45], v21 offset:8192
    ds_read_b64_tr_b16 v[46:47], v21 offset:9216
    ds_read_b64_tr_b16 v[48:49], v22 offset:8192
    ds_read_b64_tr_b16 v[50:51], v22 offset:9216
    s_waitcnt lgkmcnt(6)
    v_mfma_f32_32x32x16_bf16 a[0:15], v[52:55], v[36:39], a[0:15]
    v_mfma_f32_32x32x16_bf16 a[16:31], v[56:59], v[36:39], a[16:31]
    v_mfma_f32_32x32x16_bf16 a[32:47], v[52:55], v[40:43], a[32:47]
    v_mfma_f32_32x32x16_bf16 a[48:63], v[56:59], v[40:43], a[48:63]
    ds_read_b128 v[36:39], v20 offset:0
    ds_read_b128 v[40:43], v20 offset:4096
    ds_read_b64_tr_b16 v[52:53], v21 offset:12288
    ds_read_b64_tr_b16 v[54:55], v21 offset:13312
    ds_read_b64_tr_b16 v[56:57], v22 offset:12288
    ds_read_b64_tr_b16 v[58:59], v22 offset:13312
    s_waitcnt lgkmcnt(6)
    v_mfma_f32_32x32x16_bf16 a[0:15], v[44:47], v[28:31], a[0:15]
    v_mfma_f32_32x32x16_bf16 a[16:31], v[48:51], v[28:31], a[16:31]
    v_mfma_f32_32x32x16_bf16 a[32:47], v[44:47], v[32:35], a[32:47]
    v_mfma_f32_32x32x16_bf16 a[48:63], v[48:51], v[32:35], a[48:63]
    s_waitcnt lgkmcnt(0)
    s_waitcnt vmcnt(8)
    s_barrier
    s_mul_i32 s44, s40, 4096
    s_add_u32 m0, s44, 32768
    s_add_u32 s43, s41, 896
    buffer_load_dwordx4 v8, s[8:11], s43 offen lds
    s_mul_i32 s44, s40, 4096
    s_add_u32 m0, s44, 33792
    s_add_u32 s43, s41, 11136
    buffer_load_dwordx4 v9, s[8:11], s43 offen lds
    s_mul_i32 s44, s40, 4096
    s_add_u32 m0, s44, 34816
    s_add_u32 s43, s41, 21376
    buffer_load_dwordx4 v8, s[8:11], s43 offen lds
    s_mul_i32 s44, s40, 4096
    s_add_u32 m0, s44, 35840
    s_add_u32 s43, s41, 31616
    buffer_load_dwordx4 v9, s[8:11], s43 offen lds
    s_lshl_b32 s44, s40, 12
    s_add_u32 m0, s44, 49152
    s_mul_i32 s43, s26, 448
    s_add_u32 s43, s43, s42
    buffer_load_dwordx4 v10, s[12:15], s43 offen lds
    s_lshl_b32 s44, s40, 12
    s_add_u32 m0, s44, 50176
    s_mul_i32 s43, s26, 452
    s_add_u32 s43, s43, s42
    buffer_load_dwordx4 v10, s[12:15], s43 offen lds
    s_lshl_b32 s44, s40, 12
    s_add_u32 m0, s44, 51200
    s_mul_i32 s43, s26, 456
    s_add_u32 s43, s43, s42
    buffer_load_dwordx4 v10, s[12:15], s43 offen lds
    s_lshl_b32 s44, s40, 12
    s_add_u32 m0, s44, 52224
    s_mul_i32 s43, s26, 460
    s_add_u32 s43, s43, s42
    buffer_load_dwordx4 v10, s[12:15], s43 offen lds
    v_add_u32 v17, 65536, v11
    v_add_u32 v18, 65536, v12
    v_add_u32 v19, 65536, v13
    v_add_u32 v20, 65536, v14
    v_add_u32 v21, 65536, v15
    v_add_u32 v22, 65536, v16
    ds_read_b128 v[28:31], v17 offset:0
    ds_read_b128 v[32:35], v17 offset:4096
    ds_read_b64_tr_b16 v[44:45], v21 offset:0
    ds_read_b64_tr_b16 v[46:47], v21 offset:1024
    ds_read_b64_tr_b16 v[48:49], v22 offset:0
    ds_read_b64_tr_b16 v[50:51], v22 offset:1024
    v_mfma_f32_32x32x16_bf16 a[0:15], v[52:55], v[36:39], a[0:15]
    v_mfma_f32_32x32x16_bf16 a[16:31], v[56:59], v[36:39], a[16:31]
    v_mfma_f32_32x32x16_bf16 a[32:47], v[52:55], v[40:43], a[32:47]
    v_mfma_f32_32x32x16_bf16 a[48:63], v[56:59], v[40:43], a[48:63]
    ds_read_b128 v[36:39], v18 offset:0
    ds_read_b128 v[40:43], v18 offset:4096
    ds_read_b64_tr_b16 v[52:53], v21 offset:4096
    ds_read_b64_tr_b16 v[54:55], v21 offset:5120
    ds_read_b64_tr_b16 v[56:57], v22 offset:4096
    ds_read_b64_tr_b16 v[58:59], v22 offset:5120
    s_waitcnt lgkmcnt(6)
    v_mfma_f32_32x32x16_bf16 a[0:15], v[44:47], v[28:31], a[0:15]
    v_mfma_f32_32x32x16_bf16 a[16:31], v[48:51], v[28:31], a[16:31]
    v_mfma_f32_32x32x16_bf16 a[32:47], v[44:47], v[32:35], a[32:47]
    v_mfma_f32_32x32x16_bf16 a[48:63], v[48:51], v[32:35], a[48:63]
    ds_read_b128 v[28:31], v19 offset:0
    ds_read_b128 v[32:35], v19 offset:4096
    ds_read_b64_tr_b16 v[44:45], v21 offset:8192
    ds_read_b64_tr_b16 v[46:47], v21 offset:9216
    ds_read_b64_tr_b16 v[48:49], v22 offset:8192
    ds_read_b64_tr_b16 v[50:51], v22 offset:9216
    s_waitcnt lgkmcnt(6)
    v_mfma_f32_32x32x16_bf16 a[0:15], v[52:55], v[36:39], a[0:15]
    v_mfma_f32_32x32x16_bf16 a[16:31], v[56:59], v[36:39], a[16:31]
    v_mfma_f32_32x32x16_bf16 a[32:47], v[52:55], v[40:43], a[32:47]
    v_mfma_f32_32x32x16_bf16 a[48:63], v[56:59], v[40:43], a[48:63]
    ds_read_b128 v[36:39], v20 offset:0
    ds_read_b128 v[40:43], v20 offset:4096
    ds_read_b64_tr_b16 v[52:53], v21 offset:12288
    ds_read_b64_tr_b16 v[54:55], v21 offset:13312
    ds_read_b64_tr_b16 v[56:57], v22 offset:12288
    ds_read_b64_tr_b16 v[58:59], v22 offset:13312
    s_waitcnt lgkmcnt(6)
    v_mfma_f32_32x32x16_bf16 a[0:15], v[44:47], v[28:31], a[0:15]
    v_mfma_f32_32x32x16_bf16 a[16:31], v[48:51], v[28:31], a[16:31]
    v_mfma_f32_32x32x16_bf16 a[32:47], v[44:47], v[32:35], a[32:47]
    v_mfma_f32_32x32x16_bf16 a[48:63], v[48:51], v[32:35], a[48:63]
    s_waitcnt lgkmcnt(0)
    s_waitcnt vmcnt(8)
    s_barrier
    s_mul_i32 s44, s40, 4096
    s_add_u32 m0, s44, 65536
    s_add_u32 s43, s41, 1024
    buffer_load_dwordx4 v8, s[8:11], s43 offen lds
    s_mul_i32 s44, s40, 4096
    s_add_u32 m0, s44, 66560
    s_add_u32 s43, s41, 11264
    buffer_load_dwordx4 v9, s[8:11], s43 offen lds
    s_mul_i32 s44, s40, 4096
    s_add_u32 m0, s44, 67584
    s_add_u32 s43, s41, 21504
    buffer_load_dwordx4 v8, s[8:11], s43 offen lds
    s_mul_i32 s44, s40, 4096
    s_add_u32 m0, s44, 68608
    s_add_u32 s43, s41, 31744
    buffer_load_dwordx4 v9, s[8:11], s43 offen lds
    s_lshl_b32 s44, s40, 12
    s_add_u32 m0, s44, 81920
    s_mul_i32 s43, s26, 512
    s_add_u32 s43, s43, s42
    buffer_load_dwordx4 v10, s[12:15], s43 offen lds
    s_lshl_b32 s44, s40, 12
    s_add_u32 m0, s44, 82944
    s_mul_i32 s43, s26, 516
    s_add_u32 s43, s43, s42
    buffer_load_dwordx4 v10, s[12:15], s43 offen lds
    s_lshl_b32 s44, s40, 12
    s_add_u32 m0, s44, 83968
    s_mul_i32 s43, s26, 520
    s_add_u32 s43, s43, s42
    buffer_load_dwordx4 v10, s[12:15], s43 offen lds
    s_lshl_b32 s44, s40, 12
    s_add_u32 m0, s44, 84992
    s_mul_i32 s43, s26, 524
    s_add_u32 s43, s43, s42
    buffer_load_dwordx4 v10, s[12:15], s43 offen lds
    v_add_u32 v17, 0, v11
    v_add_u32 v18, 0, v12
    v_add_u32 v19, 0, v13
    v_add_u32 v20, 0, v14
    v_add_u32 v21, 0, v15
    v_add_u32 v22, 0, v16
    ds_read_b128 v[28:31], v17 offset:0
    ds_read_b128 v[32:35], v17 offset:4096
    ds_read_b64_tr_b16 v[44:45], v21 offset:0
    ds_read_b64_tr_b16 v[46:47], v21 offset:1024
    ds_read_b64_tr_b16 v[48:49], v22 offset:0
    ds_read_b64_tr_b16 v[50:51], v22 offset:1024
    v_mfma_f32_32x32x16_bf16 a[0:15], v[52:55], v[36:39], a[0:15]
    v_mfma_f32_32x32x16_bf16 a[16:31], v[56:59], v[36:39], a[16:31]
    v_mfma_f32_32x32x16_bf16 a[32:47], v[52:55], v[40:43], a[32:47]
    v_mfma_f32_32x32x16_bf16 a[48:63], v[56:59], v[40:43], a[48:63]
    ds_read_b128 v[36:39], v18 offset:0
    ds_read_b128 v[40:43], v18 offset:4096
    ds_read_b64_tr_b16 v[52:53], v21 offset:4096
    ds_read_b64_tr_b16 v[54:55], v21 offset:5120
    ds_read_b64_tr_b16 v[56:57], v22 offset:4096
    ds_read_b64_tr_b16 v[58:59], v22 offset:5120
    s_waitcnt lgkmcnt(6)
    v_mfma_f32_32x32x16_bf16 a[0:15], v[44:47], v[28:31], a[0:15]
    v_mfma_f32_32x32x16_bf16 a[16:31], v[48:51], v[28:31], a[16:31]
    v_mfma_f32_32x32x16_bf16 a[32:47], v[44:47], v[32:35], a[32:47]
    v_mfma_f32_32x32x16_bf16 a[48:63], v[48:51], v[32:35], a[48:63]
    ds_read_b128 v[28:31], v19 offset:0
    ds_read_b128 v[32:35], v19 offset:4096
    ds_read_b64_tr_b16 v[44:45], v21 offset:8192
    ds_read_b64_tr_b16 v[46:47], v21 offset:9216
    ds_read_b64_tr_b16 v[48:49], v22 offset:8192
    ds_read_b64_tr_b16 v[50:51], v22 offset:9216
    s_waitcnt lgkmcnt(6)
    v_mfma_f32_32x32x16_bf16 a[0:15], v[52:55], v[36:39], a[0:15]
    v_mfma_f32_32x32x16_bf16 a[16:31], v[56:59], v[36:39], a[16:31]
    v_mfma_f32_32x32x16_bf16 a[32:47], v[52:55], v[40:43], a[32:47]
    v_mfma_f32_32x32x16_bf16 a[48:63], v[56:59], v[40:43], a[48:63]
    ds_read_b128 v[36:39], v20 offset:0
    ds_read_b128 v[40:43], v20 offset:4096
    ds_read_b64_tr_b16 v[52:53], v21 offset:12288
    ds_read_b64_tr_b16 v[54:55], v21 offset:13312
    ds_read_b64_tr_b16 v[56:57], v22 offset:12288
    ds_read_b64_tr_b16 v[58:59], v22 offset:13312
    s_waitcnt lgkmcnt(6)
    v_mfma_f32_32x32x16_bf16 a[0:15], v[44:47], v[28:31], a[0:15]
    v_mfma_f32_32x32x16_bf16 a[16:31], v[48:51], v[28:31], a[16:31]
    v_mfma_f32_32x32x16_bf16 a[32:47], v[44:47], v[32:35], a[32:47]
    v_mfma_f32_32x32x16_bf16 a[48:63], v[48:51], v[32:35], a[48:63]
    s_waitcnt lgkmcnt(0)
    s_waitcnt vmcnt(8)
    s_barrier
    s_mul_i32 s44, s40, 4096
    s_add_u32 m0, s44, 0
    s_add_u32 s43, s41, 1152
    buffer_load_dwordx4 v8, s[8:11], s43 offen lds
    s_mul_i32 s44, s40, 4096
    s_add_u32 m0, s44, 1024
    s_add_u32 s43, s41, 11392
    buffer_load_dwordx4 v9, s[8:11], s43 offen lds
    s_mul_i32 s44, s40, 4096
    s_add_u32 m0, s44, 2048
    s_add_u32 s43, s41, 21632
    buffer_load_dwordx4 v8, s[8:11], s43 offen lds
    s_mul_i32 s44, s40, 4096
    s_add_u32 m0, s44, 3072
    s_add_u32 s43, s41, 31872
    buffer_load_dwordx4 v9, s[8:11], s43 offen lds
    s_lshl_b32 s44, s40, 12
    s_add_u32 m0, s44, 16384
    s_mul_i32 s43, s26, 576
    s_add_u32 s43, s43, s42
    buffer_load_dwordx4 v10, s[12:15], s43 offen lds
    s_lshl_b32 s44, s40, 12
    s_add_u32 m0, s44, 17408
    s_mul_i32 s43, s26, 580
    s_add_u32 s43, s43, s42
    buffer_load_dwordx4 v10, s[12:15], s43 offen lds
    s_lshl_b32 s44, s40, 12
    s_add_u32 m0, s44, 18432
    s_mul_i32 s43, s26, 584
    s_add_u32 s43, s43, s42
    buffer_load_dwordx4 v10, s[12:15], s43 offen lds
    s_lshl_b32 s44, s40, 12
    s_add_u32 m0, s44, 19456
    s_mul_i32 s43, s26, 588
    s_add_u32 s43, s43, s42
    buffer_load_dwordx4 v10, s[12:15], s43 offen lds
    v_add_u32 v17, 32768, v11
    v_add_u32 v18, 32768, v12
    v_add_u32 v19, 32768, v13
    v_add_u32 v20, 32768, v14
    v_add_u32 v21, 32768, v15
    v_add_u32 v22, 32768, v16
    ds_read_b128 v[28:31], v17 offset:0
    ds_read_b128 v[32:35], v17 offset:4096
    ds_read_b64_tr_b16 v[44:45], v21 offset:0
    ds_read_b64_tr_b16 v[46:47], v21 offset:1024
    ds_read_b64_tr_b16 v[48:49], v22 offset:0
    ds_read_b64_tr_b16 v[50:51], v22 offset:1024
    v_mfma_f32_32x32x16_bf16 a[0:15], v[52:55], v[36:39], a[0:15]
    v_mfma_f32_32x32x16_bf16 a[16:31], v[56:59], v[36:39], a[16:31]
    v_mfma_f32_32x32x16_bf16 a[32:47], v[52:55], v[40:43], a[32:47]
    v_mfma_f32_32x32x16_bf16 a[48:63], v[56:59], v[40:43], a[48:63]
    ds_read_b128 v[36:39], v18 offset:0
    ds_read_b128 v[40:43], v18 offset:4096
    ds_read_b64_tr_b16 v[52:53], v21 offset:4096
    ds_read_b64_tr_b16 v[54:55], v21 offset:5120
    ds_read_b64_tr_b16 v[56:57], v22 offset:4096
    ds_read_b64_tr_b16 v[58:59], v22 offset:5120
    s_waitcnt lgkmcnt(6)
    v_mfma_f32_32x32x16_bf16 a[0:15], v[44:47], v[28:31], a[0:15]
    v_mfma_f32_32x32x16_bf16 a[16:31], v[48:51], v[28:31], a[16:31]
    v_mfma_f32_32x32x16_bf16 a[32:47], v[44:47], v[32:35], a[32:47]
    v_mfma_f32_32x32x16_bf16 a[48:63], v[48:51], v[32:35], a[48:63]
    ds_read_b128 v[28:31], v19 offset:0
    ds_read_b128 v[32:35], v19 offset:4096
    ds_read_b64_tr_b16 v[44:45], v21 offset:8192
    ds_read_b64_tr_b16 v[46:47], v21 offset:9216
    ds_read_b64_tr_b16 v[48:49], v22 offset:8192
    ds_read_b64_tr_b16 v[50:51], v22 offset:9216
    s_waitcnt lgkmcnt(6)
    v_mfma_f32_32x32x16_bf16 a[0:15], v[52:55], v[36:39], a[0:15]
    v_mfma_f32_32x32x16_bf16 a[16:31], v[56:59], v[36:39], a[16:31]
    v_mfma_f32_32x32x16_bf16 a[32:47], v[52:55], v[40:43], a[32:47]
    v_mfma_f32_32x32x16_bf16 a[48:63], v[56:59], v[40:43], a[48:63]
    ds_read_b128 v[36:39], v20 offset:0
    ds_read_b128 v[40:43], v20 offset:4096
    ds_read_b64_tr_b16 v[52:53], v21 offset:12288
    ds_read_b64_tr_b16 v[54:55], v21 offset:13312
    ds_read_b64_tr_b16 v[56:57], v22 offset:12288
    ds_read_b64_tr_b16 v[58:59], v22 offset:13312
    s_waitcnt lgkmcnt(6)
    v_mfma_f32_32x32x16_bf16 a[0:15], v[44:47], v[28:31], a[0:15]
    v_mfma_f32_32x32x16_bf16 a[16:31], v[48:51], v[28:31], a[16:31]
    v_mfma_f32_32x32x16_bf16 a[32:47], v[44:47], v[32:35], a[32:47]
    v_mfma_f32_32x32x16_bf16 a[48:63], v[48:51], v[32:35], a[48:63]
    s_waitcnt lgkmcnt(0)
    s_waitcnt vmcnt(8)
    s_barrier
    v_add_u32 v17, 65536, v11
    v_add_u32 v18, 65536, v12
    v_add_u32 v19, 65536, v13
    v_add_u32 v20, 65536, v14
    v_add_u32 v21, 65536, v15
    v_add_u32 v22, 65536, v16
    ds_read_b128 v[28:31], v17 offset:0
    ds_read_b128 v[32:35], v17 offset:4096
    ds_read_b64_tr_b16 v[44:45], v21 offset:0
    ds_read_b64_tr_b16 v[46:47], v21 offset:1024
    ds_read_b64_tr_b16 v[48:49], v22 offset:0
    ds_read_b64_tr_b16 v[50:51], v22 offset:1024
    v_mfma_f32_32x32x16_bf16 a[0:15], v[52:55], v[36:39], a[0:15]
    v_mfma_f32_32x32x16_bf16 a[16:31], v[56:59], v[36:39], a[16:31]
    v_mfma_f32_32x32x16_bf16 a[32:47], v[52:55], v[40:43], a[32:47]
    v_mfma_f32_32x32x16_bf16 a[48:63], v[56:59], v[40:43], a[48:63]
    ds_read_b128 v[36:39], v18 offset:0
    ds_read_b128 v[40:43], v18 offset:4096
    ds_read_b64_tr_b16 v[52:53], v21 offset:4096
    ds_read_b64_tr_b16 v[54:55], v21 offset:5120
    ds_read_b64_tr_b16 v[56:57], v22 offset:4096
    ds_read_b64_tr_b16 v[58:59], v22 offset:5120
    s_waitcnt lgkmcnt(6)
    v_mfma_f32_32x32x16_bf16 a[0:15], v[44:47], v[28:31], a[0:15]
    v_mfma_f32_32x32x16_bf16 a[16:31], v[48:51], v[28:31], a[16:31]
    v_mfma_f32_32x32x16_bf16 a[32:47], v[44:47], v[32:35], a[32:47]
    v_mfma_f32_32x32x16_bf16 a[48:63], v[48:51], v[32:35], a[48:63]
    ds_read_b128 v[28:31], v19 offset:0
    ds_read_b128 v[32:35], v19 offset:4096
    ds_read_b64_tr_b16 v[44:45], v21 offset:8192
    ds_read_b64_tr_b16 v[46:47], v21 offset:9216
    ds_read_b64_tr_b16 v[48:49], v22 offset:8192
    ds_read_b64_tr_b16 v[50:51], v22 offset:9216
    s_waitcnt lgkmcnt(6)
    v_mfma_f32_32x32x16_bf16 a[0:15], v[52:55], v[36:39], a[0:15]
    v_mfma_f32_32x32x16_bf16 a[16:31], v[56:59], v[36:39], a[16:31]
    v_mfma_f32_32x32x16_bf16 a[32:47], v[52:55], v[40:43], a[32:47]
    v_mfma_f32_32x32x16_bf16 a[48:63], v[56:59], v[40:43], a[48:63]
    ds_read_b128 v[36:39], v20 offset:0
    ds_read_b128 v[40:43], v20 offset:4096
    ds_read_b64_tr_b16 v[52:53], v21 offset:12288
    ds_read_b64_tr_b16 v[54:55], v21 offset:13312
    ds_read_b64_tr_b16 v[56:57], v22 offset:12288
    ds_read_b64_tr_b16 v[58:59], v22 offset:13312
    s_waitcnt lgkmcnt(6)
    v_mfma_f32_32x32x16_bf16 a[0:15], v[44:47], v[28:31], a[0:15]
    v_mfma_f32_32x32x16_bf16 a[16:31], v[48:51], v[28:31], a[16:31]
    v_mfma_f32_32x32x16_bf16 a[32:47], v[44:47], v[32:35], a[32:47]
    v_mfma_f32_32x32x16_bf16 a[48:63], v[48:51], v[32:35], a[48:63]
    s_waitcnt lgkmcnt(0)
    s_waitcnt vmcnt(0)
    s_barrier
    v_add_u32 v17, 0, v11
    v_add_u32 v18, 0, v12
    v_add_u32 v19, 0, v13
    v_add_u32 v20, 0, v14
    v_add_u32 v21, 0, v15
    v_add_u32 v22, 0, v16
    ds_read_b128 v[28:31], v17 offset:0
    ds_read_b128 v[32:35], v17 offset:4096
    ds_read_b64_tr_b16 v[44:45], v21 offset:0
    ds_read_b64_tr_b16 v[46:47], v21 offset:1024
    ds_read_b64_tr_b16 v[48:49], v22 offset:0
    ds_read_b64_tr_b16 v[50:51], v22 offset:1024
    v_mfma_f32_32x32x16_bf16 a[0:15], v[52:55], v[36:39], a[0:15]
    v_mfma_f32_32x32x16_bf16 a[16:31], v[56:59], v[36:39], a[16:31]
    v_mfma_f32_32x32x16_bf16 a[32:47], v[52:55], v[40:43], a[32:47]
    v_mfma_f32_32x32x16_bf16 a[48:63], v[56:59], v[40:43], a[48:63]
    ds_read_b128 v[36:39], v18 offset:0
    ds_read_b128 v[40:43], v18 offset:4096
    ds_read_b64_tr_b16 v[52:53], v21 offset:4096
    ds_read_b64_tr_b16 v[54:55], v21 offset:5120
    ds_read_b64_tr_b16 v[56:57], v22 offset:4096
    ds_read_b64_tr_b16 v[58:59], v22 offset:5120
    s_waitcnt lgkmcnt(6)
    v_mfma_f32_32x32x16_bf16 a[0:15], v[44:47], v[28:31], a[0:15]
    v_mfma_f32_32x32x16_bf16 a[16:31], v[48:51], v[28:31], a[16:31]
    v_mfma_f32_32x32x16_bf16 a[32:47], v[44:47], v[32:35], a[32:47]
    v_mfma_f32_32x32x16_bf16 a[48:63], v[48:51], v[32:35], a[48:63]
    ds_read_b128 v[28:31], v19 offset:0
    ds_read_b128 v[32:35], v19 offset:4096
    ds_read_b64_tr_b16 v[44:45], v21 offset:8192
    ds_read_b64_tr_b16 v[46:47], v21 offset:9216
    ds_read_b64_tr_b16 v[48:49], v22 offset:8192
    ds_read_b64_tr_b16 v[50:51], v22 offset:9216
    s_waitcnt lgkmcnt(6)
    v_mfma_f32_32x32x16_bf16 a[0:15], v[52:55], v[36:39], a[0:15]
    v_mfma_f32_32x32x16_bf16 a[16:31], v[56:59], v[36:39], a[16:31]
    v_mfma_f32_32x32x16_bf16 a[32:47], v[52:55], v[40:43], a[32:47]
    v_mfma_f32_32x32x16_bf16 a[48:63], v[56:59], v[40:43], a[48:63]
    ds_read_b128 v[36:39], v20 offset:0
    ds_read_b128 v[40:43], v20 offset:4096
    ds_read_b64_tr_b16 v[52:53], v21 offset:12288
    ds_read_b64_tr_b16 v[54:55], v21 offset:13312
    ds_read_b64_tr_b16 v[56:57], v22 offset:12288
    ds_read_b64_tr_b16 v[58:59], v22 offset:13312
    s_waitcnt lgkmcnt(6)
    v_mfma_f32_32x32x16_bf16 a[0:15], v[44:47], v[28:31], a[0:15]
    v_mfma_f32_32x32x16_bf16 a[16:31], v[48:51], v[28:31], a[16:31]
    v_mfma_f32_32x32x16_bf16 a[32:47], v[44:47], v[32:35], a[32:47]
    v_mfma_f32_32x32x16_bf16 a[48:63], v[48:51], v[32:35], a[48:63]
    s_waitcnt lgkmcnt(0)
    v_mfma_f32_32x32x16_bf16 a[0:15], v[52:55], v[36:39], a[0:15]
    v_mfma_f32_32x32x16_bf16 a[16:31], v[56:59], v[36:39], a[16:31]
    v_mfma_f32_32x32x16_bf16 a[32:47], v[52:55], v[40:43], a[32:47]
    v_mfma_f32_32x32x16_bf16 a[48:63], v[56:59], v[40:43], a[48:63]
    v_lshrrev_b32 v5, 4, v0
    v_and_b32 v6, 15, v0
    s_lshl_b32 s30, s21, 7
    v_add_u32 v7, s30, v5
    v_mul_u32_u24 v7, 1280, v7
    v_lshl_add_u32 v7, v6, 4, v7
    s_lshl_b32 s31, s20, 8
    v_add_u32 v7, s31, v7
    v_lshlrev_b32 v2, 1, v7
    s_mov_b32 s31, 0
    s_mov_b32 s32, 5242880
    s_mov_b32 s33, 0
    buffer_load_dwordx4 v[68:71], v2, s[16:19], s31 offen
    buffer_load_dwordx4 v[72:75], v2, s[16:19], s31 offen offset:16
    buffer_load_dwordx4 v[76:79], v2, s[16:19], s32 offen
    buffer_load_dwordx4 v[80:83], v2, s[16:19], s32 offen offset:16
    buffer_load_dwordx4 v[84:87], v7, s[48:51], s33 offen
    s_mov_b32 s31, 40960
    s_mov_b32 s32, 5283840
    s_mov_b32 s33, 20480
    buffer_load_dwordx4 v[88:91], v2, s[16:19], s31 offen
    buffer_load_dwordx4 v[92:95], v2, s[16:19], s31 offen offset:16
    buffer_load_dwordx4 v[96:99], v2, s[16:19], s32 offen
    buffer_load_dwordx4 v[100:103], v2, s[16:19], s32 offen offset:16
    buffer_load_dwordx4 v[104:107], v7, s[48:51], s33 offen
    s_mov_b32 s31, 81920
    s_mov_b32 s32, 5324800
    s_mov_b32 s33, 40960
    buffer_load_dwordx4 v[108:111], v2, s[16:19], s31 offen
    buffer_load_dwordx4 v[112:115], v2, s[16:19], s31 offen offset:16
    buffer_load_dwordx4 v[116:119], v2, s[16:19], s32 offen
    buffer_load_dwordx4 v[120:123], v2, s[16:19], s32 offen offset:16
    buffer_load_dwordx4 v[124:127], v7, s[48:51], s33 offen
    s_mov_b32 s31, 122880
    s_mov_b32 s32, 5365760
    s_mov_b32 s33, 61440
    buffer_load_dwordx4 v[128:131], v2, s[16:19], s31 offen
    buffer_load_dwordx4 v[132:135], v2, s[16:19], s31 offen offset:16
    buffer_load_dwordx4 v[136:139], v2, s[16:19], s32 offen
    buffer_load_dwordx4 v[140:143], v2, s[16:19], s32 offen offset:16
    buffer_load_dwordx4 v[144:147], v7, s[48:51], s33 offen
    s_mov_b32 s31, 163840
    s_mov_b32 s32, 5406720
    s_mov_b32 s33, 81920
    buffer_load_dwordx4 v[148:151], v2, s[16:19], s31 offen
    buffer_load_dwordx4 v[152:155], v2, s[16:19], s31 offen offset:16
    buffer_load_dwordx4 v[156:159], v2, s[16:19], s32 offen
    buffer_load_dwordx4 v[160:163], v2, s[16:19], s32 offen offset:16
    buffer_load_dwordx4 v[164:167], v7, s[48:51], s33 offen
    s_mov_b32 s31, 204800
    s_mov_b32 s32, 5447680
    s_mov_b32 s33, 102400
    buffer_load_dwordx4 v[168:171], v2, s[16:19], s31 offen
    buffer_load_dwordx4 v[172:175], v2, s[16:19], s31 offen offset:16
    buffer_load_dwordx4 v[176:179], v2, s[16:19], s32 offen
    buffer_load_dwordx4 v[180:183], v2, s[16:19], s32 offen offset:16
    buffer_load_dwordx4 v[184:187], v7, s[48:51], s33 offen
    s_mov_b32 s31, 245760
    s_mov_b32 s32, 5488640
    s_mov_b32 s33, 122880
    buffer_load_dwordx4 v[188:191], v2, s[16:19], s31 offen
    buffer_load_dwordx4 v[192:195], v2, s[16:19], s31 offen offset:16
    buffer_load_dwordx4 v[196:199], v2, s[16:19], s32 offen
    buffer_load_dwordx4 v[200:203], v2, s[16:19], s32 offen offset:16
    buffer_load_dwordx4 v[204:207], v7, s[48:51], s33 offen
    s_mov_b32 s31, 286720
    s_mov_b32 s32, 5529600
    s_mov_b32 s33, 143360
    buffer_load_dwordx4 v[208:211], v2, s[16:19], s31 offen
    buffer_load_dwordx4 v[212:215], v2, s[16:19], s31 offen offset:16
    buffer_load_dwordx4 v[216:219], v2, s[16:19], s32 offen
    buffer_load_dwordx4 v[220:223], v2, s[16:19], s32 offen offset:16
    buffer_load_dwordx4 v[224:227], v7, s[48:51], s33 offen
    s_nop 15
    s_waitcnt lgkmcnt(0)
    s_barrier
    v_and_b32 v3, 63, v0
    v_and_b32 v4, 31, v3
    s_lshr_b32 s30, s40, 1
    s_mul_i32 s30, s30, 64
    v_add_u32 v4, s30, v4
    v_mul_u32_u24 v1, 272, v4
    v_lshrrev_b32 v4, 5, v3
    v_mul_u32_u24 v4, 8, v4
    v_add_u32 v1, v4, v1
    s_and_b32 s30, s40, 1
    s_mul_i32 s30, s30, 128
    v_add_u32 v1, s30, v1
    v_accvgpr_read_b32 v60, a0
    v_accvgpr_read_b32 v61, a1
    v_accvgpr_read_b32 v62, a2
    v_accvgpr_read_b32 v63, a3
    v_cvt_pk_bf16_f32 v64, v60, v61
    v_cvt_pk_bf16_f32 v65, v62, v63
    ds_write_b64 v1, v[64:65] offset:0
    v_accvgpr_read_b32 v60, a4
    v_accvgpr_read_b32 v61, a5
    v_accvgpr_read_b32 v62, a6
    v_accvgpr_read_b32 v63, a7
    v_cvt_pk_bf16_f32 v64, v60, v61
    v_cvt_pk_bf16_f32 v65, v62, v63
    ds_write_b64 v1, v[64:65] offset:16
    v_accvgpr_read_b32 v60, a8
    v_accvgpr_read_b32 v61, a9
    v_accvgpr_read_b32 v62, a10
    v_accvgpr_read_b32 v63, a11
    v_cvt_pk_bf16_f32 v64, v60, v61
    v_cvt_pk_bf16_f32 v65, v62, v63
    ds_write_b64 v1, v[64:65] offset:32
    v_accvgpr_read_b32 v60, a12
    v_accvgpr_read_b32 v61, a13
    v_accvgpr_read_b32 v62, a14
    v_accvgpr_read_b32 v63, a15
    v_cvt_pk_bf16_f32 v64, v60, v61
    v_cvt_pk_bf16_f32 v65, v62, v63
    ds_write_b64 v1, v[64:65] offset:48
    v_accvgpr_read_b32 v60, a16
    v_accvgpr_read_b32 v61, a17
    v_accvgpr_read_b32 v62, a18
    v_accvgpr_read_b32 v63, a19
    v_cvt_pk_bf16_f32 v64, v60, v61
    v_cvt_pk_bf16_f32 v65, v62, v63
    ds_write_b64 v1, v[64:65] offset:64
    v_accvgpr_read_b32 v60, a20
    v_accvgpr_read_b32 v61, a21
    v_accvgpr_read_b32 v62, a22
    v_accvgpr_read_b32 v63, a23
    v_cvt_pk_bf16_f32 v64, v60, v61
    v_cvt_pk_bf16_f32 v65, v62, v63
    ds_write_b64 v1, v[64:65] offset:80
    v_accvgpr_read_b32 v60, a24
    v_accvgpr_read_b32 v61, a25
    v_accvgpr_read_b32 v62, a26
    v_accvgpr_read_b32 v63, a27
    v_cvt_pk_bf16_f32 v64, v60, v61
    v_cvt_pk_bf16_f32 v65, v62, v63
    ds_write_b64 v1, v[64:65] offset:96
    v_accvgpr_read_b32 v60, a28
    v_accvgpr_read_b32 v61, a29
    v_accvgpr_read_b32 v62, a30
    v_accvgpr_read_b32 v63, a31
    v_cvt_pk_bf16_f32 v64, v60, v61
    v_cvt_pk_bf16_f32 v65, v62, v63
    ds_write_b64 v1, v[64:65] offset:112
    v_accvgpr_read_b32 v60, a32
    v_accvgpr_read_b32 v61, a33
    v_accvgpr_read_b32 v62, a34
    v_accvgpr_read_b32 v63, a35
    v_cvt_pk_bf16_f32 v64, v60, v61
    v_cvt_pk_bf16_f32 v65, v62, v63
    ds_write_b64 v1, v[64:65] offset:8704
    v_accvgpr_read_b32 v60, a36
    v_accvgpr_read_b32 v61, a37
    v_accvgpr_read_b32 v62, a38
    v_accvgpr_read_b32 v63, a39
    v_cvt_pk_bf16_f32 v64, v60, v61
    v_cvt_pk_bf16_f32 v65, v62, v63
    ds_write_b64 v1, v[64:65] offset:8720
    v_accvgpr_read_b32 v60, a40
    v_accvgpr_read_b32 v61, a41
    v_accvgpr_read_b32 v62, a42
    v_accvgpr_read_b32 v63, a43
    v_cvt_pk_bf16_f32 v64, v60, v61
    v_cvt_pk_bf16_f32 v65, v62, v63
    ds_write_b64 v1, v[64:65] offset:8736
    v_accvgpr_read_b32 v60, a44
    v_accvgpr_read_b32 v61, a45
    v_accvgpr_read_b32 v62, a46
    v_accvgpr_read_b32 v63, a47
    v_cvt_pk_bf16_f32 v64, v60, v61
    v_cvt_pk_bf16_f32 v65, v62, v63
    ds_write_b64 v1, v[64:65] offset:8752
    v_accvgpr_read_b32 v60, a48
    v_accvgpr_read_b32 v61, a49
    v_accvgpr_read_b32 v62, a50
    v_accvgpr_read_b32 v63, a51
    v_cvt_pk_bf16_f32 v64, v60, v61
    v_cvt_pk_bf16_f32 v65, v62, v63
    ds_write_b64 v1, v[64:65] offset:8768
    v_accvgpr_read_b32 v60, a52
    v_accvgpr_read_b32 v61, a53
    v_accvgpr_read_b32 v62, a54
    v_accvgpr_read_b32 v63, a55
    v_cvt_pk_bf16_f32 v64, v60, v61
    v_cvt_pk_bf16_f32 v65, v62, v63
    ds_write_b64 v1, v[64:65] offset:8784
    v_accvgpr_read_b32 v60, a56
    v_accvgpr_read_b32 v61, a57
    v_accvgpr_read_b32 v62, a58
    v_accvgpr_read_b32 v63, a59
    v_cvt_pk_bf16_f32 v64, v60, v61
    v_cvt_pk_bf16_f32 v65, v62, v63
    ds_write_b64 v1, v[64:65] offset:8800
    v_accvgpr_read_b32 v60, a60
    v_accvgpr_read_b32 v61, a61
    v_accvgpr_read_b32 v62, a62
    v_accvgpr_read_b32 v63, a63
    v_cvt_pk_bf16_f32 v64, v60, v61
    v_cvt_pk_bf16_f32 v65, v62, v63
    ds_write_b64 v1, v[64:65] offset:8816
    s_waitcnt lgkmcnt(0)
    s_barrier
    v_mul_u32_u24 v1, 272, v5
    v_lshl_add_u32 v1, v6, 4, v1
    s_waitcnt vmcnt(0)
    ds_read_b128 v[60:63], v1 offset:0
    v_add_f32 v68, v68, v76
    v_mul_f32 v76, 0xbfb8aa3b, v68
    v_add_f32 v69, v69, v77
    v_mul_f32 v77, 0xbfb8aa3b, v69
    v_add_f32 v70, v70, v78
    v_mul_f32 v78, 0xbfb8aa3b, v70
    v_add_f32 v71, v71, v79
    v_mul_f32 v79, 0xbfb8aa3b, v71
    v_add_f32 v72, v72, v80
    v_mul_f32 v80, 0xbfb8aa3b, v72
    v_add_f32 v73, v73, v81
    v_mul_f32 v81, 0xbfb8aa3b, v73
    v_add_f32 v74, v74, v82
    v_mul_f32 v82, 0xbfb8aa3b, v74
    v_add_f32 v75, v75, v83
    v_mul_f32 v83, 0xbfb8aa3b, v75
    v_exp_f32 v76, v76
    v_exp_f32 v77, v77
    v_exp_f32 v78, v78
    v_exp_f32 v79, v79
    v_exp_f32 v80, v80
    v_exp_f32 v81, v81
    v_exp_f32 v82, v82
    v_exp_f32 v83, v83
    s_nop 0
    v_add_f32 v76, 1.0, v76
    v_add_f32 v77, 1.0, v77
    v_add_f32 v78, 1.0, v78
    v_add_f32 v79, 1.0, v79
    v_add_f32 v80, 1.0, v80
    v_add_f32 v81, 1.0, v81
    v_add_f32 v82, 1.0, v82
    v_add_f32 v83, 1.0, v83
    v_rcp_f32 v76, v76
    v_rcp_f32 v77, v77
    v_rcp_f32 v78, v78
    v_rcp_f32 v79, v79
    v_rcp_f32 v80, v80
    v_rcp_f32 v81, v81
    v_rcp_f32 v82, v82
    v_rcp_f32 v83, v83
    s_nop 0
    v_mul_f32 v68, v68, v76
    v_mul_f32 v69, v69, v77
    v_mul_f32 v70, v70, v78
    v_mul_f32 v71, v71, v79
    v_mul_f32 v72, v72, v80
    v_mul_f32 v73, v73, v81
    v_mul_f32 v74, v74, v82
    v_mul_f32 v75, v75, v83
    s_waitcnt lgkmcnt(0)
    v_lshlrev_b32 v76, 16, v60
    v_and_b32 v77, 0xffff0000, v60
    v_lshlrev_b32 v64, 16, v84
    v_and_b32 v65, 0xffff0000, v84
    v_fmac_f32 v64, v76, v68
    v_fmac_f32 v65, v77, v69
    v_cvt_pk_bf16_f32 v84, v64, v65
    v_lshlrev_b32 v78, 16, v61
    v_and_b32 v79, 0xffff0000, v61
    v_lshlrev_b32 v64, 16, v85
    v_and_b32 v65, 0xffff0000, v85
    v_fmac_f32 v64, v78, v70
    v_fmac_f32 v65, v79, v71
    v_cvt_pk_bf16_f32 v85, v64, v65
    v_lshlrev_b32 v80, 16, v62
    v_and_b32 v81, 0xffff0000, v62
    v_lshlrev_b32 v64, 16, v86
    v_and_b32 v65, 0xffff0000, v86
    v_fmac_f32 v64, v80, v72
    v_fmac_f32 v65, v81, v73
    v_cvt_pk_bf16_f32 v86, v64, v65
    v_lshlrev_b32 v82, 16, v63
    v_and_b32 v83, 0xffff0000, v63
    v_lshlrev_b32 v64, 16, v87
    v_and_b32 v65, 0xffff0000, v87
    v_fmac_f32 v64, v82, v74
    v_fmac_f32 v65, v83, v75
    v_cvt_pk_bf16_f32 v87, v64, v65
    s_mov_b32 s33, 0
    buffer_store_dwordx4 v[84:87], v7, s[52:55], s33 offen
    ds_read_b128 v[60:63], v1 offset:4352
    v_add_f32 v88, v88, v96
    v_mul_f32 v96, 0xbfb8aa3b, v88
    v_add_f32 v89, v89, v97
    v_mul_f32 v97, 0xbfb8aa3b, v89
    v_add_f32 v90, v90, v98
    v_mul_f32 v98, 0xbfb8aa3b, v90
    v_add_f32 v91, v91, v99
    v_mul_f32 v99, 0xbfb8aa3b, v91
    v_add_f32 v92, v92, v100
    v_mul_f32 v100, 0xbfb8aa3b, v92
    v_add_f32 v93, v93, v101
    v_mul_f32 v101, 0xbfb8aa3b, v93
    v_add_f32 v94, v94, v102
    v_mul_f32 v102, 0xbfb8aa3b, v94
    v_add_f32 v95, v95, v103
    v_mul_f32 v103, 0xbfb8aa3b, v95
    v_exp_f32 v96, v96
    v_exp_f32 v97, v97
    v_exp_f32 v98, v98
    v_exp_f32 v99, v99
    v_exp_f32 v100, v100
    v_exp_f32 v101, v101
    v_exp_f32 v102, v102
    v_exp_f32 v103, v103
    s_nop 0
    v_add_f32 v96, 1.0, v96
    v_add_f32 v97, 1.0, v97
    v_add_f32 v98, 1.0, v98
    v_add_f32 v99, 1.0, v99
    v_add_f32 v100, 1.0, v100
    v_add_f32 v101, 1.0, v101
    v_add_f32 v102, 1.0, v102
    v_add_f32 v103, 1.0, v103
    v_rcp_f32 v96, v96
    v_rcp_f32 v97, v97
    v_rcp_f32 v98, v98
    v_rcp_f32 v99, v99
    v_rcp_f32 v100, v100
    v_rcp_f32 v101, v101
    v_rcp_f32 v102, v102
    v_rcp_f32 v103, v103
    s_nop 0
    v_mul_f32 v88, v88, v96
    v_mul_f32 v89, v89, v97
    v_mul_f32 v90, v90, v98
    v_mul_f32 v91, v91, v99
    v_mul_f32 v92, v92, v100
    v_mul_f32 v93, v93, v101
    v_mul_f32 v94, v94, v102
    v_mul_f32 v95, v95, v103
    s_waitcnt lgkmcnt(0)
    v_lshlrev_b32 v96, 16, v60
    v_and_b32 v97, 0xffff0000, v60
    v_lshlrev_b32 v64, 16, v104
    v_and_b32 v65, 0xffff0000, v104
    v_fmac_f32 v64, v96, v88
    v_fmac_f32 v65, v97, v89
    v_cvt_pk_bf16_f32 v104, v64, v65
    v_lshlrev_b32 v98, 16, v61
    v_and_b32 v99, 0xffff0000, v61
    v_lshlrev_b32 v64, 16, v105
    v_and_b32 v65, 0xffff0000, v105
    v_fmac_f32 v64, v98, v90
    v_fmac_f32 v65, v99, v91
    v_cvt_pk_bf16_f32 v105, v64, v65
    v_lshlrev_b32 v100, 16, v62
    v_and_b32 v101, 0xffff0000, v62
    v_lshlrev_b32 v64, 16, v106
    v_and_b32 v65, 0xffff0000, v106
    v_fmac_f32 v64, v100, v92
    v_fmac_f32 v65, v101, v93
    v_cvt_pk_bf16_f32 v106, v64, v65
    v_lshlrev_b32 v102, 16, v63
    v_and_b32 v103, 0xffff0000, v63
    v_lshlrev_b32 v64, 16, v107
    v_and_b32 v65, 0xffff0000, v107
    v_fmac_f32 v64, v102, v94
    v_fmac_f32 v65, v103, v95
    v_cvt_pk_bf16_f32 v107, v64, v65
    s_mov_b32 s33, 20480
    buffer_store_dwordx4 v[104:107], v7, s[52:55], s33 offen
    ds_read_b128 v[60:63], v1 offset:8704
    v_add_f32 v108, v108, v116
    v_mul_f32 v116, 0xbfb8aa3b, v108
    v_add_f32 v109, v109, v117
    v_mul_f32 v117, 0xbfb8aa3b, v109
    v_add_f32 v110, v110, v118
    v_mul_f32 v118, 0xbfb8aa3b, v110
    v_add_f32 v111, v111, v119
    v_mul_f32 v119, 0xbfb8aa3b, v111
    v_add_f32 v112, v112, v120
    v_mul_f32 v120, 0xbfb8aa3b, v112
    v_add_f32 v113, v113, v121
    v_mul_f32 v121, 0xbfb8aa3b, v113
    v_add_f32 v114, v114, v122
    v_mul_f32 v122, 0xbfb8aa3b, v114
    v_add_f32 v115, v115, v123
    v_mul_f32 v123, 0xbfb8aa3b, v115
    v_exp_f32 v116, v116
    v_exp_f32 v117, v117
    v_exp_f32 v118, v118
    v_exp_f32 v119, v119
    v_exp_f32 v120, v120
    v_exp_f32 v121, v121
    v_exp_f32 v122, v122
    v_exp_f32 v123, v123
    s_nop 0
    v_add_f32 v116, 1.0, v116
    v_add_f32 v117, 1.0, v117
    v_add_f32 v118, 1.0, v118
    v_add_f32 v119, 1.0, v119
    v_add_f32 v120, 1.0, v120
    v_add_f32 v121, 1.0, v121
    v_add_f32 v122, 1.0, v122
    v_add_f32 v123, 1.0, v123
    v_rcp_f32 v116, v116
    v_rcp_f32 v117, v117
    v_rcp_f32 v118, v118
    v_rcp_f32 v119, v119
    v_rcp_f32 v120, v120
    v_rcp_f32 v121, v121
    v_rcp_f32 v122, v122
    v_rcp_f32 v123, v123
    s_nop 0
    v_mul_f32 v108, v108, v116
    v_mul_f32 v109, v109, v117
    v_mul_f32 v110, v110, v118
    v_mul_f32 v111, v111, v119
    v_mul_f32 v112, v112, v120
    v_mul_f32 v113, v113, v121
    v_mul_f32 v114, v114, v122
    v_mul_f32 v115, v115, v123
    s_waitcnt lgkmcnt(0)
    v_lshlrev_b32 v116, 16, v60
    v_and_b32 v117, 0xffff0000, v60
    v_lshlrev_b32 v64, 16, v124
    v_and_b32 v65, 0xffff0000, v124
    v_fmac_f32 v64, v116, v108
    v_fmac_f32 v65, v117, v109
    v_cvt_pk_bf16_f32 v124, v64, v65
    v_lshlrev_b32 v118, 16, v61
    v_and_b32 v119, 0xffff0000, v61
    v_lshlrev_b32 v64, 16, v125
    v_and_b32 v65, 0xffff0000, v125
    v_fmac_f32 v64, v118, v110
    v_fmac_f32 v65, v119, v111
    v_cvt_pk_bf16_f32 v125, v64, v65
    v_lshlrev_b32 v120, 16, v62
    v_and_b32 v121, 0xffff0000, v62
    v_lshlrev_b32 v64, 16, v126
    v_and_b32 v65, 0xffff0000, v126
    v_fmac_f32 v64, v120, v112
    v_fmac_f32 v65, v121, v113
    v_cvt_pk_bf16_f32 v126, v64, v65
    v_lshlrev_b32 v122, 16, v63
    v_and_b32 v123, 0xffff0000, v63
    v_lshlrev_b32 v64, 16, v127
    v_and_b32 v65, 0xffff0000, v127
    v_fmac_f32 v64, v122, v114
    v_fmac_f32 v65, v123, v115
    v_cvt_pk_bf16_f32 v127, v64, v65
    s_mov_b32 s33, 40960
    buffer_store_dwordx4 v[124:127], v7, s[52:55], s33 offen
    ds_read_b128 v[60:63], v1 offset:13056
    v_add_f32 v128, v128, v136
    v_mul_f32 v136, 0xbfb8aa3b, v128
    v_add_f32 v129, v129, v137
    v_mul_f32 v137, 0xbfb8aa3b, v129
    v_add_f32 v130, v130, v138
    v_mul_f32 v138, 0xbfb8aa3b, v130
    v_add_f32 v131, v131, v139
    v_mul_f32 v139, 0xbfb8aa3b, v131
    v_add_f32 v132, v132, v140
    v_mul_f32 v140, 0xbfb8aa3b, v132
    v_add_f32 v133, v133, v141
    v_mul_f32 v141, 0xbfb8aa3b, v133
    v_add_f32 v134, v134, v142
    v_mul_f32 v142, 0xbfb8aa3b, v134
    v_add_f32 v135, v135, v143
    v_mul_f32 v143, 0xbfb8aa3b, v135
    v_exp_f32 v136, v136
    v_exp_f32 v137, v137
    v_exp_f32 v138, v138
    v_exp_f32 v139, v139
    v_exp_f32 v140, v140
    v_exp_f32 v141, v141
    v_exp_f32 v142, v142
    v_exp_f32 v143, v143
    s_nop 0
    v_add_f32 v136, 1.0, v136
    v_add_f32 v137, 1.0, v137
    v_add_f32 v138, 1.0, v138
    v_add_f32 v139, 1.0, v139
    v_add_f32 v140, 1.0, v140
    v_add_f32 v141, 1.0, v141
    v_add_f32 v142, 1.0, v142
    v_add_f32 v143, 1.0, v143
    v_rcp_f32 v136, v136
    v_rcp_f32 v137, v137
    v_rcp_f32 v138, v138
    v_rcp_f32 v139, v139
    v_rcp_f32 v140, v140
    v_rcp_f32 v141, v141
    v_rcp_f32 v142, v142
    v_rcp_f32 v143, v143
    s_nop 0
    v_mul_f32 v128, v128, v136
    v_mul_f32 v129, v129, v137
    v_mul_f32 v130, v130, v138
    v_mul_f32 v131, v131, v139
    v_mul_f32 v132, v132, v140
    v_mul_f32 v133, v133, v141
    v_mul_f32 v134, v134, v142
    v_mul_f32 v135, v135, v143
    s_waitcnt lgkmcnt(0)
    v_lshlrev_b32 v136, 16, v60
    v_and_b32 v137, 0xffff0000, v60
    v_lshlrev_b32 v64, 16, v144
    v_and_b32 v65, 0xffff0000, v144
    v_fmac_f32 v64, v136, v128
    v_fmac_f32 v65, v137, v129
    v_cvt_pk_bf16_f32 v144, v64, v65
    v_lshlrev_b32 v138, 16, v61
    v_and_b32 v139, 0xffff0000, v61
    v_lshlrev_b32 v64, 16, v145
    v_and_b32 v65, 0xffff0000, v145
    v_fmac_f32 v64, v138, v130
    v_fmac_f32 v65, v139, v131
    v_cvt_pk_bf16_f32 v145, v64, v65
    v_lshlrev_b32 v140, 16, v62
    v_and_b32 v141, 0xffff0000, v62
    v_lshlrev_b32 v64, 16, v146
    v_and_b32 v65, 0xffff0000, v146
    v_fmac_f32 v64, v140, v132
    v_fmac_f32 v65, v141, v133
    v_cvt_pk_bf16_f32 v146, v64, v65
    v_lshlrev_b32 v142, 16, v63
    v_and_b32 v143, 0xffff0000, v63
    v_lshlrev_b32 v64, 16, v147
    v_and_b32 v65, 0xffff0000, v147
    v_fmac_f32 v64, v142, v134
    v_fmac_f32 v65, v143, v135
    v_cvt_pk_bf16_f32 v147, v64, v65
    s_mov_b32 s33, 61440
    buffer_store_dwordx4 v[144:147], v7, s[52:55], s33 offen
    ds_read_b128 v[60:63], v1 offset:17408
    v_add_f32 v148, v148, v156
    v_mul_f32 v156, 0xbfb8aa3b, v148
    v_add_f32 v149, v149, v157
    v_mul_f32 v157, 0xbfb8aa3b, v149
    v_add_f32 v150, v150, v158
    v_mul_f32 v158, 0xbfb8aa3b, v150
    v_add_f32 v151, v151, v159
    v_mul_f32 v159, 0xbfb8aa3b, v151
    v_add_f32 v152, v152, v160
    v_mul_f32 v160, 0xbfb8aa3b, v152
    v_add_f32 v153, v153, v161
    v_mul_f32 v161, 0xbfb8aa3b, v153
    v_add_f32 v154, v154, v162
    v_mul_f32 v162, 0xbfb8aa3b, v154
    v_add_f32 v155, v155, v163
    v_mul_f32 v163, 0xbfb8aa3b, v155
    v_exp_f32 v156, v156
    v_exp_f32 v157, v157
    v_exp_f32 v158, v158
    v_exp_f32 v159, v159
    v_exp_f32 v160, v160
    v_exp_f32 v161, v161
    v_exp_f32 v162, v162
    v_exp_f32 v163, v163
    s_nop 0
    v_add_f32 v156, 1.0, v156
    v_add_f32 v157, 1.0, v157
    v_add_f32 v158, 1.0, v158
    v_add_f32 v159, 1.0, v159
    v_add_f32 v160, 1.0, v160
    v_add_f32 v161, 1.0, v161
    v_add_f32 v162, 1.0, v162
    v_add_f32 v163, 1.0, v163
    v_rcp_f32 v156, v156
    v_rcp_f32 v157, v157
    v_rcp_f32 v158, v158
    v_rcp_f32 v159, v159
    v_rcp_f32 v160, v160
    v_rcp_f32 v161, v161
    v_rcp_f32 v162, v162
    v_rcp_f32 v163, v163
    s_nop 0
    v_mul_f32 v148, v148, v156
    v_mul_f32 v149, v149, v157
    v_mul_f32 v150, v150, v158
    v_mul_f32 v151, v151, v159
    v_mul_f32 v152, v152, v160
    v_mul_f32 v153, v153, v161
    v_mul_f32 v154, v154, v162
    v_mul_f32 v155, v155, v163
    s_waitcnt lgkmcnt(0)
    v_lshlrev_b32 v156, 16, v60
    v_and_b32 v157, 0xffff0000, v60
    v_lshlrev_b32 v64, 16, v164
    v_and_b32 v65, 0xffff0000, v164
    v_fmac_f32 v64, v156, v148
    v_fmac_f32 v65, v157, v149
    v_cvt_pk_bf16_f32 v164, v64, v65
    v_lshlrev_b32 v158, 16, v61
    v_and_b32 v159, 0xffff0000, v61
    v_lshlrev_b32 v64, 16, v165
    v_and_b32 v65, 0xffff0000, v165
    v_fmac_f32 v64, v158, v150
    v_fmac_f32 v65, v159, v151
    v_cvt_pk_bf16_f32 v165, v64, v65
    v_lshlrev_b32 v160, 16, v62
    v_and_b32 v161, 0xffff0000, v62
    v_lshlrev_b32 v64, 16, v166
    v_and_b32 v65, 0xffff0000, v166
    v_fmac_f32 v64, v160, v152
    v_fmac_f32 v65, v161, v153
    v_cvt_pk_bf16_f32 v166, v64, v65
    v_lshlrev_b32 v162, 16, v63
    v_and_b32 v163, 0xffff0000, v63
    v_lshlrev_b32 v64, 16, v167
    v_and_b32 v65, 0xffff0000, v167
    v_fmac_f32 v64, v162, v154
    v_fmac_f32 v65, v163, v155
    v_cvt_pk_bf16_f32 v167, v64, v65
    s_mov_b32 s33, 81920
    buffer_store_dwordx4 v[164:167], v7, s[52:55], s33 offen
    ds_read_b128 v[60:63], v1 offset:21760
    v_add_f32 v168, v168, v176
    v_mul_f32 v176, 0xbfb8aa3b, v168
    v_add_f32 v169, v169, v177
    v_mul_f32 v177, 0xbfb8aa3b, v169
    v_add_f32 v170, v170, v178
    v_mul_f32 v178, 0xbfb8aa3b, v170
    v_add_f32 v171, v171, v179
    v_mul_f32 v179, 0xbfb8aa3b, v171
    v_add_f32 v172, v172, v180
    v_mul_f32 v180, 0xbfb8aa3b, v172
    v_add_f32 v173, v173, v181
    v_mul_f32 v181, 0xbfb8aa3b, v173
    v_add_f32 v174, v174, v182
    v_mul_f32 v182, 0xbfb8aa3b, v174
    v_add_f32 v175, v175, v183
    v_mul_f32 v183, 0xbfb8aa3b, v175
    v_exp_f32 v176, v176
    v_exp_f32 v177, v177
    v_exp_f32 v178, v178
    v_exp_f32 v179, v179
    v_exp_f32 v180, v180
    v_exp_f32 v181, v181
    v_exp_f32 v182, v182
    v_exp_f32 v183, v183
    s_nop 0
    v_add_f32 v176, 1.0, v176
    v_add_f32 v177, 1.0, v177
    v_add_f32 v178, 1.0, v178
    v_add_f32 v179, 1.0, v179
    v_add_f32 v180, 1.0, v180
    v_add_f32 v181, 1.0, v181
    v_add_f32 v182, 1.0, v182
    v_add_f32 v183, 1.0, v183
    v_rcp_f32 v176, v176
    v_rcp_f32 v177, v177
    v_rcp_f32 v178, v178
    v_rcp_f32 v179, v179
    v_rcp_f32 v180, v180
    v_rcp_f32 v181, v181
    v_rcp_f32 v182, v182
    v_rcp_f32 v183, v183
    s_nop 0
    v_mul_f32 v168, v168, v176
    v_mul_f32 v169, v169, v177
    v_mul_f32 v170, v170, v178
    v_mul_f32 v171, v171, v179
    v_mul_f32 v172, v172, v180
    v_mul_f32 v173, v173, v181
    v_mul_f32 v174, v174, v182
    v_mul_f32 v175, v175, v183
    s_waitcnt lgkmcnt(0)
    v_lshlrev_b32 v176, 16, v60
    v_and_b32 v177, 0xffff0000, v60
    v_lshlrev_b32 v64, 16, v184
    v_and_b32 v65, 0xffff0000, v184
    v_fmac_f32 v64, v176, v168
    v_fmac_f32 v65, v177, v169
    v_cvt_pk_bf16_f32 v184, v64, v65
    v_lshlrev_b32 v178, 16, v61
    v_and_b32 v179, 0xffff0000, v61
    v_lshlrev_b32 v64, 16, v185
    v_and_b32 v65, 0xffff0000, v185
    v_fmac_f32 v64, v178, v170
    v_fmac_f32 v65, v179, v171
    v_cvt_pk_bf16_f32 v185, v64, v65
    v_lshlrev_b32 v180, 16, v62
    v_and_b32 v181, 0xffff0000, v62
    v_lshlrev_b32 v64, 16, v186
    v_and_b32 v65, 0xffff0000, v186
    v_fmac_f32 v64, v180, v172
    v_fmac_f32 v65, v181, v173
    v_cvt_pk_bf16_f32 v186, v64, v65
    v_lshlrev_b32 v182, 16, v63
    v_and_b32 v183, 0xffff0000, v63
    v_lshlrev_b32 v64, 16, v187
    v_and_b32 v65, 0xffff0000, v187
    v_fmac_f32 v64, v182, v174
    v_fmac_f32 v65, v183, v175
    v_cvt_pk_bf16_f32 v187, v64, v65
    s_mov_b32 s33, 102400
    buffer_store_dwordx4 v[184:187], v7, s[52:55], s33 offen
    ds_read_b128 v[60:63], v1 offset:26112
    v_add_f32 v188, v188, v196
    v_mul_f32 v196, 0xbfb8aa3b, v188
    v_add_f32 v189, v189, v197
    v_mul_f32 v197, 0xbfb8aa3b, v189
    v_add_f32 v190, v190, v198
    v_mul_f32 v198, 0xbfb8aa3b, v190
    v_add_f32 v191, v191, v199
    v_mul_f32 v199, 0xbfb8aa3b, v191
    v_add_f32 v192, v192, v200
    v_mul_f32 v200, 0xbfb8aa3b, v192
    v_add_f32 v193, v193, v201
    v_mul_f32 v201, 0xbfb8aa3b, v193
    v_add_f32 v194, v194, v202
    v_mul_f32 v202, 0xbfb8aa3b, v194
    v_add_f32 v195, v195, v203
    v_mul_f32 v203, 0xbfb8aa3b, v195
    v_exp_f32 v196, v196
    v_exp_f32 v197, v197
    v_exp_f32 v198, v198
    v_exp_f32 v199, v199
    v_exp_f32 v200, v200
    v_exp_f32 v201, v201
    v_exp_f32 v202, v202
    v_exp_f32 v203, v203
    s_nop 0
    v_add_f32 v196, 1.0, v196
    v_add_f32 v197, 1.0, v197
    v_add_f32 v198, 1.0, v198
    v_add_f32 v199, 1.0, v199
    v_add_f32 v200, 1.0, v200
    v_add_f32 v201, 1.0, v201
    v_add_f32 v202, 1.0, v202
    v_add_f32 v203, 1.0, v203
    v_rcp_f32 v196, v196
    v_rcp_f32 v197, v197
    v_rcp_f32 v198, v198
    v_rcp_f32 v199, v199
    v_rcp_f32 v200, v200
    v_rcp_f32 v201, v201
    v_rcp_f32 v202, v202
    v_rcp_f32 v203, v203
    s_nop 0
    v_mul_f32 v188, v188, v196
    v_mul_f32 v189, v189, v197
    v_mul_f32 v190, v190, v198
    v_mul_f32 v191, v191, v199
    v_mul_f32 v192, v192, v200
    v_mul_f32 v193, v193, v201
    v_mul_f32 v194, v194, v202
    v_mul_f32 v195, v195, v203
    s_waitcnt lgkmcnt(0)
    v_lshlrev_b32 v196, 16, v60
    v_and_b32 v197, 0xffff0000, v60
    v_lshlrev_b32 v64, 16, v204
    v_and_b32 v65, 0xffff0000, v204
    v_fmac_f32 v64, v196, v188
    v_fmac_f32 v65, v197, v189
    v_cvt_pk_bf16_f32 v204, v64, v65
    v_lshlrev_b32 v198, 16, v61
    v_and_b32 v199, 0xffff0000, v61
    v_lshlrev_b32 v64, 16, v205
    v_and_b32 v65, 0xffff0000, v205
    v_fmac_f32 v64, v198, v190
    v_fmac_f32 v65, v199, v191
    v_cvt_pk_bf16_f32 v205, v64, v65
    v_lshlrev_b32 v200, 16, v62
    v_and_b32 v201, 0xffff0000, v62
    v_lshlrev_b32 v64, 16, v206
    v_and_b32 v65, 0xffff0000, v206
    v_fmac_f32 v64, v200, v192
    v_fmac_f32 v65, v201, v193
    v_cvt_pk_bf16_f32 v206, v64, v65
    v_lshlrev_b32 v202, 16, v63
    v_and_b32 v203, 0xffff0000, v63
    v_lshlrev_b32 v64, 16, v207
    v_and_b32 v65, 0xffff0000, v207
    v_fmac_f32 v64, v202, v194
    v_fmac_f32 v65, v203, v195
    v_cvt_pk_bf16_f32 v207, v64, v65
    s_mov_b32 s33, 122880
    buffer_store_dwordx4 v[204:207], v7, s[52:55], s33 offen
    ds_read_b128 v[60:63], v1 offset:30464
    v_add_f32 v208, v208, v216
    v_mul_f32 v216, 0xbfb8aa3b, v208
    v_add_f32 v209, v209, v217
    v_mul_f32 v217, 0xbfb8aa3b, v209
    v_add_f32 v210, v210, v218
    v_mul_f32 v218, 0xbfb8aa3b, v210
    v_add_f32 v211, v211, v219
    v_mul_f32 v219, 0xbfb8aa3b, v211
    v_add_f32 v212, v212, v220
    v_mul_f32 v220, 0xbfb8aa3b, v212
    v_add_f32 v213, v213, v221
    v_mul_f32 v221, 0xbfb8aa3b, v213
    v_add_f32 v214, v214, v222
    v_mul_f32 v222, 0xbfb8aa3b, v214
    v_add_f32 v215, v215, v223
    v_mul_f32 v223, 0xbfb8aa3b, v215
    v_exp_f32 v216, v216
    v_exp_f32 v217, v217
    v_exp_f32 v218, v218
    v_exp_f32 v219, v219
    v_exp_f32 v220, v220
    v_exp_f32 v221, v221
    v_exp_f32 v222, v222
    v_exp_f32 v223, v223
    s_nop 0
    v_add_f32 v216, 1.0, v216
    v_add_f32 v217, 1.0, v217
    v_add_f32 v218, 1.0, v218
    v_add_f32 v219, 1.0, v219
    v_add_f32 v220, 1.0, v220
    v_add_f32 v221, 1.0, v221
    v_add_f32 v222, 1.0, v222
    v_add_f32 v223, 1.0, v223
    v_rcp_f32 v216, v216
    v_rcp_f32 v217, v217
    v_rcp_f32 v218, v218
    v_rcp_f32 v219, v219
    v_rcp_f32 v220, v220
    v_rcp_f32 v221, v221
    v_rcp_f32 v222, v222
    v_rcp_f32 v223, v223
    s_nop 0
    v_mul_f32 v208, v208, v216
    v_mul_f32 v209, v209, v217
    v_mul_f32 v210, v210, v218
    v_mul_f32 v211, v211, v219
    v_mul_f32 v212, v212, v220
    v_mul_f32 v213, v213, v221
    v_mul_f32 v214, v214, v222
    v_mul_f32 v215, v215, v223
    s_waitcnt lgkmcnt(0)
    v_lshlrev_b32 v216, 16, v60
    v_and_b32 v217, 0xffff0000, v60
    v_lshlrev_b32 v64, 16, v224
    v_and_b32 v65, 0xffff0000, v224
    v_fmac_f32 v64, v216, v208
    v_fmac_f32 v65, v217, v209
    v_cvt_pk_bf16_f32 v224, v64, v65
    v_lshlrev_b32 v218, 16, v61
    v_and_b32 v219, 0xffff0000, v61
    v_lshlrev_b32 v64, 16, v225
    v_and_b32 v65, 0xffff0000, v225
    v_fmac_f32 v64, v218, v210
    v_fmac_f32 v65, v219, v211
    v_cvt_pk_bf16_f32 v225, v64, v65
    v_lshlrev_b32 v220, 16, v62
    v_and_b32 v221, 0xffff0000, v62
    v_lshlrev_b32 v64, 16, v226
    v_and_b32 v65, 0xffff0000, v226
    v_fmac_f32 v64, v220, v212
    v_fmac_f32 v65, v221, v213
    v_cvt_pk_bf16_f32 v226, v64, v65
    v_lshlrev_b32 v222, 16, v63
    v_and_b32 v223, 0xffff0000, v63
    v_lshlrev_b32 v64, 16, v227
    v_and_b32 v65, 0xffff0000, v227
    v_fmac_f32 v64, v222, v214
    v_fmac_f32 v65, v223, v215
    v_cvt_pk_bf16_f32 v227, v64, v65
    s_mov_b32 s33, 143360
    buffer_store_dwordx4 v[224:227], v7, s[52:55], s33 offen
recurrent_scan__sliding_block__dense_activation_relu__prompt_kernel_done1:
    s_endpgm
.section .rodata,"a"
.p2align 6
.amdhsa_kernel ln_kernel
  .amdhsa_next_free_vgpr 76
  .amdhsa_next_free_sgpr 100
  .amdhsa_accum_offset 76
  .amdhsa_group_segment_fixed_size 0
  .amdhsa_kernarg_size 72
  .amdhsa_user_sgpr_count 2
  .amdhsa_user_sgpr_kernarg_segment_ptr 1
  .amdhsa_system_sgpr_workgroup_id_x 1
.end_amdhsa_kernel
.p2align 6
.amdhsa_kernel gemm1_kernel
  .amdhsa_next_free_vgpr 220
  .amdhsa_next_free_sgpr 100
  .amdhsa_accum_offset 92
  .amdhsa_group_segment_fixed_size 0
  .amdhsa_kernarg_size 72
  .amdhsa_user_sgpr_count 2
  .amdhsa_user_sgpr_kernarg_segment_ptr 1
  .amdhsa_system_sgpr_workgroup_id_x 1
.end_amdhsa_kernel
.p2align 6
.amdhsa_kernel mid_kernel
  .amdhsa_next_free_vgpr 276
  .amdhsa_next_free_sgpr 100
  .amdhsa_accum_offset 212
  .amdhsa_group_segment_fixed_size 0
  .amdhsa_kernarg_size 72
  .amdhsa_user_sgpr_count 2
  .amdhsa_user_sgpr_kernarg_segment_ptr 1
  .amdhsa_system_sgpr_workgroup_id_x 1
.end_amdhsa_kernel
.p2align 6
.amdhsa_kernel recurrent_scan__sliding_block__dense_activation_relu__prompt_kernel
  .amdhsa_next_free_vgpr 292
  .amdhsa_next_free_sgpr 100
  .amdhsa_accum_offset 228
  .amdhsa_group_segment_fixed_size 0
  .amdhsa_kernarg_size 72
  .amdhsa_user_sgpr_count 2
  .amdhsa_user_sgpr_kernarg_segment_ptr 1
  .amdhsa_system_sgpr_workgroup_id_x 1
.end_amdhsa_kernel
```
